```python
import torch

def _softmax(x, axis=-1):
    return torch.softmax(x, dim=axis)
def _gelu(x):
    return torch.nn.functional.gelu(x, approximate="tanh")
def _silu(x):
    return torch.nn.functional.silu(x)
def _sigmoid(x):
    return torch.sigmoid(x)
def _layernorm(x, axis=-1, eps=1e-5):
    m = x.mean(dim=axis, keepdim=True)
    v = x.var(dim=axis, keepdim=True, unbiased=False)
    return (x - m) / torch.sqrt(v + eps)
def _scatter_add(tgt, idx, src, axis=0):
    return tgt.clone().index_add_(axis, idx, src)
def _segment_sum(src, seg, n):
    out = torch.zeros((n,) + src.shape[1:], dtype=src.dtype)
    return out.index_add_(0, seg, src)
def _pad(x, pw):
    flat = tuple(v for pair in reversed(pw) for v in pair)
    return torch.nn.functional.pad(x, flat)

kernel_name = 'gated_mix__ssm_conv_s4__glu_gated_reglu__prompt'

def setup_inputs():

    _w = (lambda a: (lambda t: t.to(torch.bfloat16) if t.is_floating_point() else t)(torch.as_tensor(a)))
    def _A_setup():
        B, L, D, N = 1, 2048, 512, 128
        A_re = -(lambda _x: torch.exp(torch.as_tensor(_x)))((lambda *s: torch.randn(*s, dtype=torch.bfloat16) * 6.4)(D, N))
        A_im = torch.pi * (lambda *s: torch.randn(*s, dtype=torch.bfloat16) * 0.05)(D, N)
        B_re = (lambda *s: torch.randn(*s, dtype=torch.bfloat16) * 0.1)(D, N)
        B_im = (lambda *s: torch.randn(*s, dtype=torch.bfloat16) * 0.1)(D, N)
        C_re = (lambda *s: torch.randn(*s, dtype=torch.bfloat16) * 0.1)(D, N)
        C_im = (lambda *s: torch.randn(*s, dtype=torch.bfloat16) * 0.1)(D, N)
        log_dt = (lambda *s: torch.randn(*s, dtype=torch.bfloat16) * 0.05)(D) * 0.5 - 4.0
        Dskip = (lambda *s: torch.randn(*s, dtype=torch.bfloat16) * 0.05)(D)
        return {
            "u": _w((lambda *s: torch.randn(*s, dtype=torch.bfloat16) * 0.05)(B, L, D)),
            "A_re": _w(A_re),
            "A_im": _w(A_im),
            "B_re": _w(B_re),
            "B_im": _w(B_im),
            "C_re": _w(C_re),
            "C_im": _w(C_im),
            "log_dt": _w(log_dt),
            "Dskip": _w(Dskip),
        }
    _A_in = _A_setup()

    def _B_setup():
        B, S, D, F = 1, 2048, 512, 1376
        return {
            "x": _w((lambda *s: torch.randn(*s, dtype=torch.bfloat16) * 0.05)(B, S, D)),
            "W_gate": _w((lambda *s: torch.randn(*s, dtype=torch.bfloat16) * 0.8)(D, F) * (2.0 / D) ** 0.5),
            "W_up": _w((lambda *s: torch.randn(*s, dtype=torch.bfloat16) * 0.8)(D, F) * (2.0 / D) ** 0.5),
            "W_down": _w((lambda *s: torch.randn(*s, dtype=torch.bfloat16) * 0.8)(F, D) * (1.0 / F) ** 0.5),
        }
    _B_in = _B_setup()

    return {
        "A_u": _A_in["u"],
        "A_A_re": _A_in["A_re"],
        "A_A_im": _A_in["A_im"],
        "A_B_re": _A_in["B_re"],
        "A_B_im": _A_in["B_im"],
        "A_C_re": _A_in["C_re"],
        "A_C_im": _A_in["C_im"],
        "A_log_dt": _A_in["log_dt"],
        "A_Dskip": _A_in["Dskip"],
        "B_x": _B_in["x"],
        "B_W_gate": _B_in["W_gate"],
        "B_W_up": _B_in["W_up"],
        "B_W_down": _B_in["W_down"],
        "gate_w": _w((lambda *s: torch.randn(*s, dtype=torch.bfloat16) * 0.05)(512) * 16.0),
    }

def reference(A_u, A_A_re, A_A_im, A_B_re, A_B_im, A_C_re, A_C_im, A_log_dt, A_Dskip, B_x, B_W_gate, B_W_up, B_W_down, gate_w):
    def _A_ref(u, A_re, A_im, B_re, B_im, C_re, C_im, log_dt, Dskip):
        Bsz, L, D = u.shape
        dt = torch.exp(log_dt)[:, None]
        A = A_re + 1j * A_im
        Bc = B_re + 1j * B_im
        Cc = C_re + 1j * C_im
        logdA = dt * A
        dB = dt * Bc
        l = (lambda x, dt: x.to(dt))(torch.arange(L), A_re.dtype)
        P = torch.exp(logdA[:, :, None] * l[None, None, :])
        K = torch.einsum("dn,dnl,dn->dl", Cc, P, dB).real
        L2 = 2 * L
        Kp = _pad(K, ((0, 0), (0, L)))
        up = (lambda x, *d: x.permute(*d))(u, 0, 2, 1)
        up = _pad(up, ((0, 0), (0, 0), (0, L)))
        Kf = (lambda x, axes=(-2,-1): torch.fft.rfft2(x.float(), dim=axes))(Kp[:, None, :], axes=(-2, -1))
        Uf = (lambda x, axes=(-2,-1): torch.fft.rfft2(x.float(), dim=axes))(up[:, :, None, :], axes=(-2, -1))
        Yf = Uf * Kf[None, :, :, :]
        y = (lambda x, s, axes=(-2,-1): torch.fft.irfft2(x, s=s, dim=axes).to(torch.bfloat16))(Yf, (1, L2), axes=(-2, -1))[:, :, 0, :L]
        y = (lambda x, *d: x.permute(*d))(y, 0, 2, 1) + u * Dskip[None, None, :]
        return y

    def _B_ref(x, W_gate, W_up, W_down):
        gate = torch.einsum("bsd,df->bsf", x, W_gate)
        up = torch.einsum("bsd,df->bsf", x, W_up)
        gate = gate * (lambda x, dt: x.to(dt))(gate > 0, gate.dtype)
        h = gate * up
        return torch.einsum("bsf,fd->bsd", h, W_down)

    x = A_u
    g = _sigmoid((x * gate_w).sum(-1, keepdims=True))
    a = _A_ref(x, A_A_re, A_A_im, A_B_re, A_B_im, A_C_re, A_C_im, A_log_dt, A_Dskip)
    b = _B_ref(x, B_W_gate, B_W_up, B_W_down)
    return g * a + (1 - g) * b
```

```asm
; @launch grid=(512,1,1) block=(256,1,1) lds=81920
.amdgcn_target "amdgcn-amd-amdhsa--gfx950"
.text
.globl gated_mix__ssm_conv_s4__glu_gated_reglu__prompt_kernel
.p2align 8
.type gated_mix__ssm_conv_s4__glu_gated_reglu__prompt_kernel,@function
gated_mix__ssm_conv_s4__glu_gated_reglu__prompt_kernel:
s_cmp_ge_u32 s2, 512
s_cbranch_scc1 fz_end
s_load_dwordx2 s[66:67], s[0:1], 128
s_load_dwordx2 s[72:73], s[0:1], 120
s_and_b32 s4, s2, 255
s_cmp_lt_u32 s4, 32
s_cbranch_scc0 fz_pf_1
s_getpc_b64 s[4:5]
fz_pfh_2:
v_lshlrev_b32 v245, 7, v0
v_min_u32 v245, fz_end-fz_pfh_2, v245
v_mov_b32 v247, s5
v_add_co_u32 v246, vcc, s4, v245
s_nop 1
v_addc_co_u32 v247, vcc, 0, v247, vcc
global_load_dword v245, v[246:247], off
fz_pf_1:
s_cmp_lt_u32 s2, 256
s_cbranch_scc1 fz_ssm
s_cmp_ge_u32 s2, 496
s_cbranch_scc1 fz_g
s_sub_u32 s3, s2, 256
s_load_dwordx2 s[4:5], s[0:1], 0
s_load_dwordx2 s[6:7], s[0:1], 80
s_load_dwordx2 s[8:9], s[0:1], 88
s_load_dwordx2 s[10:11], s[0:1], 128
s_load_dwordx2 s[36:37], s[0:1], 96
v_lshrrev_b32 v2, 6, v0
v_and_b32 v1, 63, v0
v_readfirstlane_b32 s24, v2
s_and_b32 s32, s3, 7
s_mul_i32 s32, s32, 30
s_lshr_b32 s33, s3, 3
s_add_u32 s32, s32, s33
s_cmp_ge_u32 s32, 120
s_cselect_b32 s33, 120, 0
s_cselect_b32 s25, 8, 0
s_sub_u32 s32, s32, s33
s_lshr_b32 s26, s32, 3
s_and_b32 s32, s32, 7
s_add_u32 s25, s25, s32
s_and_b32 s33, s26, 3
s_lshl_b32 s33, s33, 1
s_add_u32 s27, s32, s33
s_and_b32 s27, s27, 7
s_mov_b32 s27, s32
s_and_b32 s32, s24, 1
s_lshr_b32 s33, s24, 1
s_mul_i32 s28, s32, 44032
s_mul_i32 s34, s26, 192
s_add_u32 s28, s28, s34
s_mul_i32 s30, s24, 3072
s_lshl_b32 s29, s25, 17
s_lshl_b32 s34, s24, 15
s_add_u32 s29, s29, s34
s_lshl_b32 s31, s24, 13
s_add_u32 s31, s31, 49152
v_add_u32 v2, 0, v1
v_mul_u32_u24 v3, 171, v2
v_lshrrev_b32 v3, 11, v3
v_mul_u32_u24 v4, 12, v3
v_sub_u32 v2, v2, v4
v_mul_u32_u24 v5, 2752, v3
v_lshl_add_u32 v5, v2, 4, v5
v_add_u32 v2, 64, v1
v_mul_u32_u24 v3, 171, v2
v_lshrrev_b32 v3, 11, v3
v_mul_u32_u24 v4, 12, v3
v_sub_u32 v2, v2, v4
v_mul_u32_u24 v6, 2752, v3
v_lshl_add_u32 v6, v2, 4, v6
v_add_u32 v2, 128, v1
v_mul_u32_u24 v3, 171, v2
v_lshrrev_b32 v3, 11, v3
v_mul_u32_u24 v4, 12, v3
v_sub_u32 v2, v2, v4
v_mul_u32_u24 v7, 2752, v3
v_lshl_add_u32 v7, v2, 4, v7
v_lshrrev_b32 v2, 3, v1
v_lshrrev_b32 v3, 4, v1
v_and_b32 v4, 7, v1
v_xor_b32 v3, v3, v4
v_lshlrev_b32 v8, 10, v2
v_lshl_add_u32 v8, v3, 4, v8
v_xor_b32 v9, 64, v8
v_add_u32 v9, 8192, v9
v_add_u32 v10, 16384, v8
v_add_u32 v11, 16384, v9
s_lshl_b32 s32, s27, 1
s_add_u32 s32, s32, 0
s_and_b32 s32, s32, 15
s_mul_i32 s32, s32, 88064
s_add_u32 s40, s28, s32
s_lshl_b32 s32, s27, 1
s_add_u32 s32, s32, 1
s_and_b32 s32, s32, 15
s_mul_i32 s32, s32, 88064
s_add_u32 s41, s28, s32
s_lshl_b32 s32, s27, 1
s_add_u32 s32, s32, 2
s_and_b32 s32, s32, 15
s_mul_i32 s32, s32, 88064
s_add_u32 s42, s28, s32
s_lshl_b32 s32, s27, 1
s_add_u32 s32, s32, 3
s_and_b32 s32, s32, 15
s_mul_i32 s32, s32, 88064
s_add_u32 s43, s28, s32
s_add_u32 s32, s27, 0
s_and_b32 s32, s32, 7
s_lshl_b32 s32, s32, 7
s_add_u32 s56, s29, s32
s_add_u32 s32, s27, 1
s_and_b32 s32, s32, 7
s_lshl_b32 s32, s32, 7
s_add_u32 s57, s29, s32
s_add_u32 s32, s27, 2
s_and_b32 s32, s32, 7
s_lshl_b32 s32, s32, 7
s_add_u32 s58, s29, s32
s_lshr_b32 s33, s24, 1
s_waitcnt lgkmcnt(0)
s_cmp_eq_u32 s33, 0
s_cselect_b32 s16, s6, s8
s_cselect_b32 s17, s7, s9
s_mov_b32 s18, 1409024
s_mov_b32 s19, 0x00020000
s_mov_b32 s12, s4
s_mov_b32 s13, s5
s_mov_b32 s14, 2097152
s_mov_b32 s15, 0x00020000
s_add_u32 s68, s66, 5242880
s_addc_u32 s69, s67, 0
s_mov_b32 s70, 99328
s_mov_b32 s71, 0x00020000
s_mov_b32 s74, 256
s_mov_b32 s75, 0x00020000
s_add_u32 m0, s30, 0
s_nop 0
buffer_load_dwordx4 v5, s[16:19], s40 offen lds
s_add_u32 m0, s30, 1024
s_nop 0
buffer_load_dwordx4 v6, s[16:19], s40 offen lds
s_add_u32 m0, s30, 2048
s_nop 0
buffer_load_dwordx4 v7, s[16:19], s40 offen lds
s_add_u32 m0, s31, 0
s_nop 0
buffer_load_dwordx4 v8, s[12:15], s56 offen lds
s_add_u32 m0, s31, 1024
s_nop 0
buffer_load_dwordx4 v9, s[12:15], s56 offen lds
s_add_u32 m0, s31, 2048
s_nop 0
buffer_load_dwordx4 v10, s[12:15], s56 offen lds
s_add_u32 m0, s31, 3072
s_nop 0
buffer_load_dwordx4 v11, s[12:15], s56 offen lds
s_add_u32 m0, s31, 4096
s_nop 0
buffer_load_dwordx4 v8, s[12:15], s57 offen lds
s_add_u32 m0, s31, 5120
s_nop 0
buffer_load_dwordx4 v9, s[12:15], s57 offen lds
s_add_u32 m0, s31, 6144
s_nop 0
buffer_load_dwordx4 v10, s[12:15], s57 offen lds
s_add_u32 m0, s31, 7168
s_nop 0
buffer_load_dwordx4 v11, s[12:15], s57 offen lds
s_add_u32 s20, s10, 8388608
s_addc_u32 s21, s11, 0
s_mov_b32 s22, 5636096
s_mov_b32 s23, 0x00020000
s_mov_b32 s38, 1409024
s_mov_b32 s39, 0x00020000
v_lshrrev_b32 v2, 3, v1
v_bfe_u32 v3, v1, 4, 1
v_lshlrev_b32 v3, 2, v3
v_and_b32 v4, 7, v1
v_xor_b32 v3, v3, v4
v_lshlrev_b32 v172, 10, v2
v_lshl_add_u32 v172, v3, 4, v172
s_lshr_b32 s35, s2, 5
s_add_u32 s35, s35, 4
s_and_b32 s35, s35, 7
s_lshl_b32 s35, s35, 7
s_lshl_b32 s32, s27, 1
s_add_u32 s32, s32, 4
s_and_b32 s32, s32, 15
s_mul_i32 s32, s32, 88064
s_add_u32 s44, s28, s32
s_lshl_b32 s32, s27, 1
s_add_u32 s32, s32, 5
s_and_b32 s32, s32, 15
s_mul_i32 s32, s32, 88064
s_add_u32 s45, s28, s32
s_lshl_b32 s32, s27, 1
s_add_u32 s32, s32, 6
s_and_b32 s32, s32, 15
s_mul_i32 s32, s32, 88064
s_add_u32 s46, s28, s32
s_lshl_b32 s32, s27, 1
s_add_u32 s32, s32, 7
s_and_b32 s32, s32, 15
s_mul_i32 s32, s32, 88064
s_add_u32 s47, s28, s32
s_lshl_b32 s32, s27, 1
s_add_u32 s32, s32, 8
s_and_b32 s32, s32, 15
s_mul_i32 s32, s32, 88064
s_add_u32 s48, s28, s32
s_lshl_b32 s32, s27, 1
s_add_u32 s32, s32, 9
s_and_b32 s32, s32, 15
s_mul_i32 s32, s32, 88064
s_add_u32 s49, s28, s32
s_lshl_b32 s32, s27, 1
s_add_u32 s32, s32, 10
s_and_b32 s32, s32, 15
s_mul_i32 s32, s32, 88064
s_add_u32 s50, s28, s32
s_lshl_b32 s32, s27, 1
s_add_u32 s32, s32, 11
s_and_b32 s32, s32, 15
s_mul_i32 s32, s32, 88064
s_add_u32 s51, s28, s32
s_lshl_b32 s32, s27, 1
s_add_u32 s32, s32, 12
s_and_b32 s32, s32, 15
s_mul_i32 s32, s32, 88064
s_add_u32 s52, s28, s32
s_lshl_b32 s32, s27, 1
s_add_u32 s32, s32, 13
s_and_b32 s32, s32, 15
s_mul_i32 s32, s32, 88064
s_add_u32 s53, s28, s32
s_lshl_b32 s32, s27, 1
s_add_u32 s32, s32, 14
s_and_b32 s32, s32, 15
s_mul_i32 s32, s32, 88064
s_add_u32 s54, s28, s32
s_lshl_b32 s32, s27, 1
s_add_u32 s32, s32, 15
s_and_b32 s32, s32, 15
s_mul_i32 s32, s32, 88064
s_add_u32 s55, s28, s32
s_add_u32 s32, s27, 3
s_and_b32 s32, s32, 7
s_lshl_b32 s32, s32, 7
s_add_u32 s59, s29, s32
s_add_u32 s32, s27, 4
s_and_b32 s32, s32, 7
s_lshl_b32 s32, s32, 7
s_add_u32 s60, s29, s32
s_add_u32 s32, s27, 5
s_and_b32 s32, s32, 7
s_lshl_b32 s32, s32, 7
s_add_u32 s61, s29, s32
s_add_u32 s32, s27, 6
s_and_b32 s32, s32, 7
s_lshl_b32 s32, s32, 7
s_add_u32 s62, s29, s32
s_add_u32 s32, s27, 7
s_and_b32 s32, s32, 7
s_lshl_b32 s32, s32, 7
s_add_u32 s63, s29, s32
v_and_b32 v2, 31, v1
v_lshrrev_b32 v3, 5, v1
v_bfe_u32 v4, v1, 1, 3
v_xor_b32 v4, v4, v3
v_lshlrev_b32 v2, 7, v2
v_lshl_add_u32 v2, v4, 4, v2
v_xor_b32 v12, 0, v2
v_add_u32 v12, s31, v12
v_xor_b32 v13, 32, v2
v_add_u32 v13, s31, v13
v_xor_b32 v14, 64, v2
v_add_u32 v14, s31, v14
v_xor_b32 v15, 96, v2
v_add_u32 v15, s31, v15
v_lshlrev_b32 v3, 3, v3
v_bfe_u32 v4, v1, 2, 2
v_add_u32 v3, v3, v4
v_mul_u32_u24 v16, 192, v3
v_bfe_u32 v4, v1, 4, 1
v_lshl_add_u32 v16, v4, 5, v16
v_and_b32 v4, 3, v1
v_lshl_add_u32 v16, v4, 3, v16
s_setprio 3
s_add_u32 m0, s30, 12288
s_nop 0
buffer_load_dwordx4 v5, s[16:19], s41 offen lds
s_add_u32 m0, s30, 13312
s_nop 0
buffer_load_dwordx4 v6, s[16:19], s41 offen lds
s_add_u32 m0, s30, 14336
s_nop 0
buffer_load_dwordx4 v7, s[16:19], s41 offen lds
s_waitcnt vmcnt(7)
ds_read_b128 v[140:143], v12 offset:0
ds_read_b128 v[144:147], v13 offset:0
ds_read_b128 v[148:151], v14 offset:0
ds_read_b128 v[152:155], v15 offset:0
s_barrier
ds_read_b64_tr_b16 v[116:117], v16 offset:0
ds_read_b64_tr_b16 v[118:119], v16 offset:768
ds_read_b64_tr_b16 v[120:121], v16 offset:64
ds_read_b64_tr_b16 v[122:123], v16 offset:832
ds_read_b64_tr_b16 v[124:125], v16 offset:128
ds_read_b64_tr_b16 v[126:127], v16 offset:896
ds_read_b64_tr_b16 v[128:129], v16 offset:6144
ds_read_b64_tr_b16 v[130:131], v16 offset:6912
s_waitcnt lgkmcnt(8)
ds_read_b64_tr_b16 v[132:133], v16 offset:6208
ds_read_b64_tr_b16 v[134:135], v16 offset:6976
s_add_u32 m0, s30, 24576
s_nop 0
buffer_load_dwordx4 v5, s[16:19], s42 offen lds
s_waitcnt lgkmcnt(8)
v_mfma_f32_32x32x16_bf16 v[20:35], v[116:119], v[140:143], 0
ds_read_b64_tr_b16 v[136:137], v16 offset:6272
ds_read_b64_tr_b16 v[138:139], v16 offset:7040
s_waitcnt vmcnt(4)
ds_read_b128 v[156:159], v12 offset:4096
ds_read_b128 v[160:163], v13 offset:4096
ds_read_b128 v[164:167], v14 offset:4096
ds_read_b128 v[168:171], v15 offset:4096
s_add_u32 m0, s30, 25600
s_nop 0
buffer_load_dwordx4 v6, s[16:19], s42 offen lds
s_waitcnt lgkmcnt(12)
v_mfma_f32_32x32x16_bf16 v[36:51], v[120:123], v[140:143], 0
ds_read_b64_tr_b16 v[116:117], v16 offset:3072
ds_read_b64_tr_b16 v[118:119], v16 offset:3840
s_add_u32 m0, s30, 26624
s_nop 0
buffer_load_dwordx4 v7, s[16:19], s42 offen lds
s_add_u32 m0, s31, 0
s_nop 0
buffer_load_dwordx4 v8, s[12:15], s58 offen lds
s_add_u32 m0, s31, 1024
s_nop 0
buffer_load_dwordx4 v9, s[12:15], s58 offen lds
s_waitcnt lgkmcnt(12)
v_mfma_f32_32x32x16_bf16 v[52:67], v[124:127], v[140:143], 0
ds_read_b64_tr_b16 v[120:121], v16 offset:3136
ds_read_b64_tr_b16 v[122:123], v16 offset:3904
s_add_u32 m0, s31, 2048
s_nop 0
buffer_load_dwordx4 v10, s[12:15], s58 offen lds
s_add_u32 m0, s31, 3072
s_nop 0
buffer_load_dwordx4 v11, s[12:15], s58 offen lds
s_waitcnt lgkmcnt(12)
v_mfma_f32_32x32x16_bf16 v[68:83], v[128:131], v[140:143], 0
ds_read_b64_tr_b16 v[124:125], v16 offset:3200
ds_read_b64_tr_b16 v[126:127], v16 offset:3968
s_waitcnt lgkmcnt(6)
s_add_u32 m0, s31, 4096
s_nop 0
buffer_load_dwordx4 v8, s[12:15], s59 offen lds
v_mfma_f32_32x32x16_bf16 v[84:99], v[132:135], v[140:143], 0
ds_read_b64_tr_b16 v[128:129], v16 offset:9216
ds_read_b64_tr_b16 v[130:131], v16 offset:9984
s_add_u32 m0, s30, 36864
s_nop 0
buffer_load_dwordx4 v5, s[16:19], s43 offen lds
v_mfma_f32_32x32x16_bf16 v[100:115], v[136:139], v[140:143], 0
ds_read_b64_tr_b16 v[132:133], v16 offset:9280
ds_read_b64_tr_b16 v[134:135], v16 offset:10048
s_add_u32 m0, s31, 5120
s_nop 0
buffer_load_dwordx4 v9, s[12:15], s59 offen lds
s_waitcnt lgkmcnt(8)
v_mfma_f32_32x32x16_bf16 v[20:35], v[116:119], v[144:147], v[20:35]
ds_read_b64_tr_b16 v[136:137], v16 offset:9344
ds_read_b64_tr_b16 v[138:139], v16 offset:10112
s_add_u32 m0, s30, 37888
s_nop 0
buffer_load_dwordx4 v6, s[16:19], s43 offen lds
s_waitcnt lgkmcnt(8)
v_mfma_f32_32x32x16_bf16 v[36:51], v[120:123], v[144:147], v[36:51]
s_waitcnt lgkmcnt(0)
s_waitcnt vmcnt(11)
s_barrier
ds_read_b64_tr_b16 v[116:117], v16 offset:12288
ds_read_b64_tr_b16 v[118:119], v16 offset:13056
s_add_u32 m0, s30, 38912
s_nop 0
buffer_load_dwordx4 v7, s[16:19], s43 offen lds
v_mfma_f32_32x32x16_bf16 v[52:67], v[124:127], v[144:147], v[52:67]
ds_read_b64_tr_b16 v[120:121], v16 offset:12352
ds_read_b64_tr_b16 v[122:123], v16 offset:13120
s_add_u32 m0, s30, 0
s_nop 0
buffer_load_dwordx4 v5, s[16:19], s44 offen lds
v_mfma_f32_32x32x16_bf16 v[68:83], v[128:131], v[144:147], v[68:83]
ds_read_b64_tr_b16 v[124:125], v16 offset:12416
ds_read_b64_tr_b16 v[126:127], v16 offset:13184
v_mfma_f32_32x32x16_bf16 v[84:99], v[132:135], v[144:147], v[84:99]
ds_read_b64_tr_b16 v[128:129], v16 offset:18432
ds_read_b64_tr_b16 v[130:131], v16 offset:19200
s_add_u32 m0, s30, 1024
s_nop 0
buffer_load_dwordx4 v6, s[16:19], s44 offen lds
v_mfma_f32_32x32x16_bf16 v[100:115], v[136:139], v[144:147], v[100:115]
ds_read_b64_tr_b16 v[132:133], v16 offset:18496
ds_read_b64_tr_b16 v[134:135], v16 offset:19264
s_waitcnt lgkmcnt(8)
v_mfma_f32_32x32x16_bf16 v[20:35], v[116:119], v[148:151], v[20:35]
ds_read_b64_tr_b16 v[136:137], v16 offset:18560
ds_read_b64_tr_b16 v[138:139], v16 offset:19328
s_add_u32 m0, s30, 2048
s_nop 0
buffer_load_dwordx4 v7, s[16:19], s44 offen lds
s_waitcnt lgkmcnt(8)
v_mfma_f32_32x32x16_bf16 v[36:51], v[120:123], v[148:151], v[36:51]
ds_read_b64_tr_b16 v[116:117], v16 offset:15360
ds_read_b64_tr_b16 v[118:119], v16 offset:16128
s_waitcnt lgkmcnt(8)
v_mfma_f32_32x32x16_bf16 v[52:67], v[124:127], v[148:151], v[52:67]
ds_read_b64_tr_b16 v[120:121], v16 offset:15424
ds_read_b64_tr_b16 v[122:123], v16 offset:16192
s_waitcnt lgkmcnt(8)
v_mfma_f32_32x32x16_bf16 v[68:83], v[128:131], v[148:151], v[68:83]
ds_read_b64_tr_b16 v[124:125], v16 offset:15488
ds_read_b64_tr_b16 v[126:127], v16 offset:16256
s_add_u32 m0, s31, 6144
s_nop 0
buffer_load_dwordx4 v10, s[12:15], s59 offen lds
s_waitcnt lgkmcnt(8)
v_mfma_f32_32x32x16_bf16 v[84:99], v[132:135], v[148:151], v[84:99]
ds_read_b64_tr_b16 v[128:129], v16 offset:21504
ds_read_b64_tr_b16 v[130:131], v16 offset:22272
s_waitcnt lgkmcnt(8)
v_mfma_f32_32x32x16_bf16 v[100:115], v[136:139], v[148:151], v[100:115]
ds_read_b64_tr_b16 v[132:133], v16 offset:21568
ds_read_b64_tr_b16 v[134:135], v16 offset:22336
s_add_u32 m0, s31, 7168
s_nop 0
buffer_load_dwordx4 v11, s[12:15], s59 offen lds
s_waitcnt lgkmcnt(8)
v_mfma_f32_32x32x16_bf16 v[20:35], v[116:119], v[152:155], v[20:35]
ds_read_b64_tr_b16 v[136:137], v16 offset:21632
ds_read_b64_tr_b16 v[138:139], v16 offset:22400
s_waitcnt lgkmcnt(8)
v_mfma_f32_32x32x16_bf16 v[36:51], v[120:123], v[152:155], v[36:51]
s_waitcnt lgkmcnt(0)
s_waitcnt vmcnt(14)
s_barrier
ds_read_b64_tr_b16 v[116:117], v16 offset:24576
ds_read_b64_tr_b16 v[118:119], v16 offset:25344
v_mfma_f32_32x32x16_bf16 v[52:67], v[124:127], v[152:155], v[52:67]
ds_read_b64_tr_b16 v[120:121], v16 offset:24640
ds_read_b64_tr_b16 v[122:123], v16 offset:25408
s_add_u32 m0, s30, 12288
s_nop 0
buffer_load_dwordx4 v5, s[16:19], s45 offen lds
v_mfma_f32_32x32x16_bf16 v[68:83], v[128:131], v[152:155], v[68:83]
ds_read_b64_tr_b16 v[124:125], v16 offset:24704
ds_read_b64_tr_b16 v[126:127], v16 offset:25472
v_mfma_f32_32x32x16_bf16 v[84:99], v[132:135], v[152:155], v[84:99]
ds_read_b64_tr_b16 v[128:129], v16 offset:30720
ds_read_b64_tr_b16 v[130:131], v16 offset:31488
s_add_u32 m0, s30, 13312
s_nop 0
buffer_load_dwordx4 v6, s[16:19], s45 offen lds
v_mfma_f32_32x32x16_bf16 v[100:115], v[136:139], v[152:155], v[100:115]
ds_read_b64_tr_b16 v[132:133], v16 offset:30784
ds_read_b64_tr_b16 v[134:135], v16 offset:31552
s_waitcnt lgkmcnt(8)
v_mfma_f32_32x32x16_bf16 v[20:35], v[116:119], v[156:159], v[20:35]
ds_read_b64_tr_b16 v[136:137], v16 offset:30848
ds_read_b64_tr_b16 v[138:139], v16 offset:31616
s_waitcnt vmcnt(12)
ds_read_b128 v[140:143], v12 offset:0
ds_read_b128 v[144:147], v13 offset:0
ds_read_b128 v[148:151], v14 offset:0
ds_read_b128 v[152:155], v15 offset:0
s_add_u32 m0, s30, 14336
s_nop 0
buffer_load_dwordx4 v7, s[16:19], s45 offen lds
s_waitcnt lgkmcnt(12)
v_mfma_f32_32x32x16_bf16 v[36:51], v[120:123], v[156:159], v[36:51]
ds_read_b64_tr_b16 v[116:117], v16 offset:27648
ds_read_b64_tr_b16 v[118:119], v16 offset:28416
s_waitcnt lgkmcnt(12)
v_mfma_f32_32x32x16_bf16 v[52:67], v[124:127], v[156:159], v[52:67]
ds_read_b64_tr_b16 v[120:121], v16 offset:27712
ds_read_b64_tr_b16 v[122:123], v16 offset:28480
s_waitcnt lgkmcnt(12)
v_mfma_f32_32x32x16_bf16 v[68:83], v[128:131], v[156:159], v[68:83]
ds_read_b64_tr_b16 v[124:125], v16 offset:27776
ds_read_b64_tr_b16 v[126:127], v16 offset:28544
s_waitcnt lgkmcnt(6)
s_add_u32 m0, s31, 0
s_nop 0
buffer_load_dwordx4 v8, s[12:15], s60 offen lds
v_mfma_f32_32x32x16_bf16 v[84:99], v[132:135], v[156:159], v[84:99]
ds_read_b64_tr_b16 v[128:129], v16 offset:33792
ds_read_b64_tr_b16 v[130:131], v16 offset:34560
v_mfma_f32_32x32x16_bf16 v[100:115], v[136:139], v[156:159], v[100:115]
ds_read_b64_tr_b16 v[132:133], v16 offset:33856
ds_read_b64_tr_b16 v[134:135], v16 offset:34624
s_add_u32 m0, s31, 1024
s_nop 0
buffer_load_dwordx4 v9, s[12:15], s60 offen lds
s_waitcnt lgkmcnt(8)
v_mfma_f32_32x32x16_bf16 v[20:35], v[116:119], v[160:163], v[20:35]
ds_read_b64_tr_b16 v[136:137], v16 offset:33920
ds_read_b64_tr_b16 v[138:139], v16 offset:34688
s_waitcnt lgkmcnt(8)
v_mfma_f32_32x32x16_bf16 v[36:51], v[120:123], v[160:163], v[36:51]
s_waitcnt lgkmcnt(0)
s_waitcnt vmcnt(10)
s_barrier
ds_read_b64_tr_b16 v[116:117], v16 offset:36864
ds_read_b64_tr_b16 v[118:119], v16 offset:37632
v_mfma_f32_32x32x16_bf16 v[52:67], v[124:127], v[160:163], v[52:67]
ds_read_b64_tr_b16 v[120:121], v16 offset:36928
ds_read_b64_tr_b16 v[122:123], v16 offset:37696
s_add_u32 m0, s30, 24576
s_nop 0
buffer_load_dwordx4 v5, s[16:19], s46 offen lds
v_mfma_f32_32x32x16_bf16 v[68:83], v[128:131], v[160:163], v[68:83]
ds_read_b64_tr_b16 v[124:125], v16 offset:36992
ds_read_b64_tr_b16 v[126:127], v16 offset:37760
v_mfma_f32_32x32x16_bf16 v[84:99], v[132:135], v[160:163], v[84:99]
ds_read_b64_tr_b16 v[128:129], v16 offset:43008
ds_read_b64_tr_b16 v[130:131], v16 offset:43776
s_add_u32 m0, s30, 25600
s_nop 0
buffer_load_dwordx4 v6, s[16:19], s46 offen lds
v_mfma_f32_32x32x16_bf16 v[100:115], v[136:139], v[160:163], v[100:115]
ds_read_b64_tr_b16 v[132:133], v16 offset:43072
ds_read_b64_tr_b16 v[134:135], v16 offset:43840
s_waitcnt lgkmcnt(8)
v_mfma_f32_32x32x16_bf16 v[20:35], v[116:119], v[164:167], v[20:35]
ds_read_b64_tr_b16 v[136:137], v16 offset:43136
ds_read_b64_tr_b16 v[138:139], v16 offset:43904
s_add_u32 m0, s30, 26624
s_nop 0
buffer_load_dwordx4 v7, s[16:19], s46 offen lds
s_waitcnt lgkmcnt(8)
v_mfma_f32_32x32x16_bf16 v[36:51], v[120:123], v[164:167], v[36:51]
ds_read_b64_tr_b16 v[116:117], v16 offset:39936
ds_read_b64_tr_b16 v[118:119], v16 offset:40704
s_waitcnt lgkmcnt(8)
v_mfma_f32_32x32x16_bf16 v[52:67], v[124:127], v[164:167], v[52:67]
ds_read_b64_tr_b16 v[120:121], v16 offset:40000
ds_read_b64_tr_b16 v[122:123], v16 offset:40768
s_waitcnt lgkmcnt(8)
v_mfma_f32_32x32x16_bf16 v[68:83], v[128:131], v[164:167], v[68:83]
ds_read_b64_tr_b16 v[124:125], v16 offset:40064
ds_read_b64_tr_b16 v[126:127], v16 offset:40832
s_add_u32 m0, s31, 2048
s_nop 0
buffer_load_dwordx4 v10, s[12:15], s60 offen lds
s_waitcnt lgkmcnt(8)
v_mfma_f32_32x32x16_bf16 v[84:99], v[132:135], v[164:167], v[84:99]
ds_read_b64_tr_b16 v[128:129], v16 offset:46080
ds_read_b64_tr_b16 v[130:131], v16 offset:46848
s_waitcnt lgkmcnt(8)
v_mfma_f32_32x32x16_bf16 v[100:115], v[136:139], v[164:167], v[100:115]
ds_read_b64_tr_b16 v[132:133], v16 offset:46144
ds_read_b64_tr_b16 v[134:135], v16 offset:46912
s_add_u32 m0, s31, 3072
s_nop 0
buffer_load_dwordx4 v11, s[12:15], s60 offen lds
s_waitcnt lgkmcnt(8)
v_mfma_f32_32x32x16_bf16 v[20:35], v[116:119], v[168:171], v[20:35]
ds_read_b64_tr_b16 v[136:137], v16 offset:46208
ds_read_b64_tr_b16 v[138:139], v16 offset:46976
s_waitcnt lgkmcnt(8)
v_mfma_f32_32x32x16_bf16 v[36:51], v[120:123], v[168:171], v[36:51]
s_waitcnt lgkmcnt(0)
s_waitcnt vmcnt(12)
s_barrier
ds_read_b64_tr_b16 v[116:117], v16 offset:0
ds_read_b64_tr_b16 v[118:119], v16 offset:768
v_mfma_f32_32x32x16_bf16 v[52:67], v[124:127], v[168:171], v[52:67]
ds_read_b64_tr_b16 v[120:121], v16 offset:64
ds_read_b64_tr_b16 v[122:123], v16 offset:832
s_add_u32 m0, s30, 36864
s_nop 0
buffer_load_dwordx4 v5, s[16:19], s47 offen lds
v_mfma_f32_32x32x16_bf16 v[68:83], v[128:131], v[168:171], v[68:83]
ds_read_b64_tr_b16 v[124:125], v16 offset:128
ds_read_b64_tr_b16 v[126:127], v16 offset:896
v_mfma_f32_32x32x16_bf16 v[84:99], v[132:135], v[168:171], v[84:99]
ds_read_b64_tr_b16 v[128:129], v16 offset:6144
ds_read_b64_tr_b16 v[130:131], v16 offset:6912
s_add_u32 m0, s30, 37888
s_nop 0
buffer_load_dwordx4 v6, s[16:19], s47 offen lds
v_mfma_f32_32x32x16_bf16 v[100:115], v[136:139], v[168:171], v[100:115]
ds_read_b64_tr_b16 v[132:133], v16 offset:6208
ds_read_b64_tr_b16 v[134:135], v16 offset:6976
s_waitcnt lgkmcnt(8)
v_mfma_f32_32x32x16_bf16 v[20:35], v[116:119], v[140:143], v[20:35]
ds_read_b64_tr_b16 v[136:137], v16 offset:6272
ds_read_b64_tr_b16 v[138:139], v16 offset:7040
s_waitcnt vmcnt(12)
ds_read_b128 v[156:159], v12 offset:4096
ds_read_b128 v[160:163], v13 offset:4096
ds_read_b128 v[164:167], v14 offset:4096
ds_read_b128 v[168:171], v15 offset:4096
s_add_u32 m0, s30, 38912
s_nop 0
buffer_load_dwordx4 v7, s[16:19], s47 offen lds
s_waitcnt lgkmcnt(12)
v_mfma_f32_32x32x16_bf16 v[36:51], v[120:123], v[140:143], v[36:51]
ds_read_b64_tr_b16 v[116:117], v16 offset:3072
ds_read_b64_tr_b16 v[118:119], v16 offset:3840
s_mul_i32 s40, s24, 360448
s_add_u32 s40, s40, s35
s_lshl_b32 s41, s24, 13
s_add_u32 s41, s41, s35
s_lshl_b32 s42, s24, 10
s_waitcnt lgkmcnt(12)
v_mfma_f32_32x32x16_bf16 v[52:67], v[124:127], v[140:143], v[52:67]
ds_read_b64_tr_b16 v[120:121], v16 offset:3136
ds_read_b64_tr_b16 v[122:123], v16 offset:3904
s_waitcnt lgkmcnt(12)
v_mfma_f32_32x32x16_bf16 v[68:83], v[128:131], v[140:143], v[68:83]
ds_read_b64_tr_b16 v[124:125], v16 offset:3200
ds_read_b64_tr_b16 v[126:127], v16 offset:3968
s_waitcnt lgkmcnt(6)
s_add_u32 m0, s31, 4096
s_nop 0
buffer_load_dwordx4 v8, s[12:15], s61 offen lds
v_mfma_f32_32x32x16_bf16 v[84:99], v[132:135], v[140:143], v[84:99]
ds_read_b64_tr_b16 v[128:129], v16 offset:9216
ds_read_b64_tr_b16 v[130:131], v16 offset:9984
v_mfma_f32_32x32x16_bf16 v[100:115], v[136:139], v[140:143], v[100:115]
ds_read_b64_tr_b16 v[132:133], v16 offset:9280
ds_read_b64_tr_b16 v[134:135], v16 offset:10048
s_add_u32 m0, s31, 5120
s_nop 0
buffer_load_dwordx4 v9, s[12:15], s61 offen lds
s_waitcnt lgkmcnt(8)
v_mfma_f32_32x32x16_bf16 v[20:35], v[116:119], v[144:147], v[20:35]
ds_read_b64_tr_b16 v[136:137], v16 offset:9344
ds_read_b64_tr_b16 v[138:139], v16 offset:10112
s_waitcnt lgkmcnt(8)
v_mfma_f32_32x32x16_bf16 v[36:51], v[120:123], v[144:147], v[36:51]
s_waitcnt lgkmcnt(0)
s_waitcnt vmcnt(12)
s_barrier
ds_read_b64_tr_b16 v[116:117], v16 offset:12288
ds_read_b64_tr_b16 v[118:119], v16 offset:13056
v_mfma_f32_32x32x16_bf16 v[52:67], v[124:127], v[144:147], v[52:67]
ds_read_b64_tr_b16 v[120:121], v16 offset:12352
ds_read_b64_tr_b16 v[122:123], v16 offset:13120
s_add_u32 m0, s30, 0
s_nop 0
buffer_load_dwordx4 v5, s[16:19], s48 offen lds
v_mfma_f32_32x32x16_bf16 v[68:83], v[128:131], v[144:147], v[68:83]
ds_read_b64_tr_b16 v[124:125], v16 offset:12416
ds_read_b64_tr_b16 v[126:127], v16 offset:13184
v_mfma_f32_32x32x16_bf16 v[84:99], v[132:135], v[144:147], v[84:99]
ds_read_b64_tr_b16 v[128:129], v16 offset:18432
ds_read_b64_tr_b16 v[130:131], v16 offset:19200
s_add_u32 m0, s30, 1024
s_nop 0
buffer_load_dwordx4 v6, s[16:19], s48 offen lds
v_mfma_f32_32x32x16_bf16 v[100:115], v[136:139], v[144:147], v[100:115]
ds_read_b64_tr_b16 v[132:133], v16 offset:18496
ds_read_b64_tr_b16 v[134:135], v16 offset:19264
s_waitcnt lgkmcnt(8)
v_mfma_f32_32x32x16_bf16 v[20:35], v[116:119], v[148:151], v[20:35]
ds_read_b64_tr_b16 v[136:137], v16 offset:18560
ds_read_b64_tr_b16 v[138:139], v16 offset:19328
s_add_u32 m0, s30, 2048
s_nop 0
buffer_load_dwordx4 v7, s[16:19], s48 offen lds
s_waitcnt lgkmcnt(8)
v_mfma_f32_32x32x16_bf16 v[36:51], v[120:123], v[148:151], v[36:51]
ds_read_b64_tr_b16 v[116:117], v16 offset:15360
ds_read_b64_tr_b16 v[118:119], v16 offset:16128
s_waitcnt lgkmcnt(8)
v_mfma_f32_32x32x16_bf16 v[52:67], v[124:127], v[148:151], v[52:67]
ds_read_b64_tr_b16 v[120:121], v16 offset:15424
ds_read_b64_tr_b16 v[122:123], v16 offset:16192
s_waitcnt lgkmcnt(8)
v_mfma_f32_32x32x16_bf16 v[68:83], v[128:131], v[148:151], v[68:83]
ds_read_b64_tr_b16 v[124:125], v16 offset:15488
ds_read_b64_tr_b16 v[126:127], v16 offset:16256
s_add_u32 m0, s31, 6144
s_nop 0
buffer_load_dwordx4 v10, s[12:15], s61 offen lds
s_waitcnt lgkmcnt(8)
v_mfma_f32_32x32x16_bf16 v[84:99], v[132:135], v[148:151], v[84:99]
ds_read_b64_tr_b16 v[128:129], v16 offset:21504
ds_read_b64_tr_b16 v[130:131], v16 offset:22272
s_waitcnt lgkmcnt(8)
v_mfma_f32_32x32x16_bf16 v[100:115], v[136:139], v[148:151], v[100:115]
ds_read_b64_tr_b16 v[132:133], v16 offset:21568
ds_read_b64_tr_b16 v[134:135], v16 offset:22336
s_add_u32 m0, s31, 7168
s_nop 0
buffer_load_dwordx4 v11, s[12:15], s61 offen lds
s_waitcnt lgkmcnt(8)
v_mfma_f32_32x32x16_bf16 v[20:35], v[116:119], v[152:155], v[20:35]
ds_read_b64_tr_b16 v[136:137], v16 offset:21632
ds_read_b64_tr_b16 v[138:139], v16 offset:22400
s_waitcnt lgkmcnt(8)
v_mfma_f32_32x32x16_bf16 v[36:51], v[120:123], v[152:155], v[36:51]
s_waitcnt lgkmcnt(0)
s_waitcnt vmcnt(12)
s_barrier
ds_read_b64_tr_b16 v[116:117], v16 offset:24576
ds_read_b64_tr_b16 v[118:119], v16 offset:25344
v_mfma_f32_32x32x16_bf16 v[52:67], v[124:127], v[152:155], v[52:67]
ds_read_b64_tr_b16 v[120:121], v16 offset:24640
ds_read_b64_tr_b16 v[122:123], v16 offset:25408
s_add_u32 m0, s30, 12288
s_nop 0
buffer_load_dwordx4 v5, s[16:19], s49 offen lds
v_mfma_f32_32x32x16_bf16 v[68:83], v[128:131], v[152:155], v[68:83]
ds_read_b64_tr_b16 v[124:125], v16 offset:24704
ds_read_b64_tr_b16 v[126:127], v16 offset:25472
v_mfma_f32_32x32x16_bf16 v[84:99], v[132:135], v[152:155], v[84:99]
ds_read_b64_tr_b16 v[128:129], v16 offset:30720
ds_read_b64_tr_b16 v[130:131], v16 offset:31488
s_add_u32 m0, s30, 13312
s_nop 0
buffer_load_dwordx4 v6, s[16:19], s49 offen lds
v_mfma_f32_32x32x16_bf16 v[100:115], v[136:139], v[152:155], v[100:115]
ds_read_b64_tr_b16 v[132:133], v16 offset:30784
ds_read_b64_tr_b16 v[134:135], v16 offset:31552
s_waitcnt lgkmcnt(8)
v_mfma_f32_32x32x16_bf16 v[20:35], v[116:119], v[156:159], v[20:35]
ds_read_b64_tr_b16 v[136:137], v16 offset:30848
ds_read_b64_tr_b16 v[138:139], v16 offset:31616
s_waitcnt vmcnt(12)
ds_read_b128 v[140:143], v12 offset:0
ds_read_b128 v[144:147], v13 offset:0
ds_read_b128 v[148:151], v14 offset:0
ds_read_b128 v[152:155], v15 offset:0
s_add_u32 m0, s30, 14336
s_nop 0
buffer_load_dwordx4 v7, s[16:19], s49 offen lds
s_waitcnt lgkmcnt(12)
v_mfma_f32_32x32x16_bf16 v[36:51], v[120:123], v[156:159], v[36:51]
ds_read_b64_tr_b16 v[116:117], v16 offset:27648
ds_read_b64_tr_b16 v[118:119], v16 offset:28416
s_waitcnt lgkmcnt(12)
v_mfma_f32_32x32x16_bf16 v[52:67], v[124:127], v[156:159], v[52:67]
ds_read_b64_tr_b16 v[120:121], v16 offset:27712
ds_read_b64_tr_b16 v[122:123], v16 offset:28480
s_waitcnt lgkmcnt(12)
v_mfma_f32_32x32x16_bf16 v[68:83], v[128:131], v[156:159], v[68:83]
ds_read_b64_tr_b16 v[124:125], v16 offset:27776
ds_read_b64_tr_b16 v[126:127], v16 offset:28544
s_waitcnt lgkmcnt(6)
s_add_u32 m0, s31, 0
s_nop 0
buffer_load_dwordx4 v8, s[12:15], s62 offen lds
v_mfma_f32_32x32x16_bf16 v[84:99], v[132:135], v[156:159], v[84:99]
ds_read_b64_tr_b16 v[128:129], v16 offset:33792
ds_read_b64_tr_b16 v[130:131], v16 offset:34560
v_mfma_f32_32x32x16_bf16 v[100:115], v[136:139], v[156:159], v[100:115]
ds_read_b64_tr_b16 v[132:133], v16 offset:33856
ds_read_b64_tr_b16 v[134:135], v16 offset:34624
s_add_u32 m0, s31, 1024
s_nop 0
buffer_load_dwordx4 v9, s[12:15], s62 offen lds
s_waitcnt lgkmcnt(8)
v_mfma_f32_32x32x16_bf16 v[20:35], v[116:119], v[160:163], v[20:35]
ds_read_b64_tr_b16 v[136:137], v16 offset:33920
ds_read_b64_tr_b16 v[138:139], v16 offset:34688
s_waitcnt lgkmcnt(8)
v_mfma_f32_32x32x16_bf16 v[36:51], v[120:123], v[160:163], v[36:51]
s_waitcnt lgkmcnt(0)
s_waitcnt vmcnt(12)
s_barrier
ds_read_b64_tr_b16 v[116:117], v16 offset:36864
ds_read_b64_tr_b16 v[118:119], v16 offset:37632
v_mfma_f32_32x32x16_bf16 v[52:67], v[124:127], v[160:163], v[52:67]
ds_read_b64_tr_b16 v[120:121], v16 offset:36928
ds_read_b64_tr_b16 v[122:123], v16 offset:37696
s_add_u32 m0, s30, 24576
s_nop 0
buffer_load_dwordx4 v5, s[16:19], s50 offen lds
v_mfma_f32_32x32x16_bf16 v[68:83], v[128:131], v[160:163], v[68:83]
ds_read_b64_tr_b16 v[124:125], v16 offset:36992
ds_read_b64_tr_b16 v[126:127], v16 offset:37760
v_mfma_f32_32x32x16_bf16 v[84:99], v[132:135], v[160:163], v[84:99]
ds_read_b64_tr_b16 v[128:129], v16 offset:43008
ds_read_b64_tr_b16 v[130:131], v16 offset:43776
s_add_u32 m0, s30, 25600
s_nop 0
buffer_load_dwordx4 v6, s[16:19], s50 offen lds
v_mfma_f32_32x32x16_bf16 v[100:115], v[136:139], v[160:163], v[100:115]
ds_read_b64_tr_b16 v[132:133], v16 offset:43072
ds_read_b64_tr_b16 v[134:135], v16 offset:43840
s_waitcnt lgkmcnt(8)
v_mfma_f32_32x32x16_bf16 v[20:35], v[116:119], v[164:167], v[20:35]
ds_read_b64_tr_b16 v[136:137], v16 offset:43136
ds_read_b64_tr_b16 v[138:139], v16 offset:43904
s_add_u32 m0, s30, 26624
s_nop 0
buffer_load_dwordx4 v7, s[16:19], s50 offen lds
s_waitcnt lgkmcnt(8)
v_mfma_f32_32x32x16_bf16 v[36:51], v[120:123], v[164:167], v[36:51]
ds_read_b64_tr_b16 v[116:117], v16 offset:39936
ds_read_b64_tr_b16 v[118:119], v16 offset:40704
s_waitcnt lgkmcnt(8)
v_mfma_f32_32x32x16_bf16 v[52:67], v[124:127], v[164:167], v[52:67]
ds_read_b64_tr_b16 v[120:121], v16 offset:40000
ds_read_b64_tr_b16 v[122:123], v16 offset:40768
s_waitcnt lgkmcnt(8)
v_mfma_f32_32x32x16_bf16 v[68:83], v[128:131], v[164:167], v[68:83]
ds_read_b64_tr_b16 v[124:125], v16 offset:40064
ds_read_b64_tr_b16 v[126:127], v16 offset:40832
s_add_u32 m0, s31, 2048
s_nop 0
buffer_load_dwordx4 v10, s[12:15], s62 offen lds
s_waitcnt lgkmcnt(8)
v_mfma_f32_32x32x16_bf16 v[84:99], v[132:135], v[164:167], v[84:99]
ds_read_b64_tr_b16 v[128:129], v16 offset:46080
ds_read_b64_tr_b16 v[130:131], v16 offset:46848
s_waitcnt lgkmcnt(8)
v_mfma_f32_32x32x16_bf16 v[100:115], v[136:139], v[164:167], v[100:115]
ds_read_b64_tr_b16 v[132:133], v16 offset:46144
ds_read_b64_tr_b16 v[134:135], v16 offset:46912
s_add_u32 m0, s31, 3072
s_nop 0
buffer_load_dwordx4 v11, s[12:15], s62 offen lds
s_waitcnt lgkmcnt(8)
v_mfma_f32_32x32x16_bf16 v[20:35], v[116:119], v[168:171], v[20:35]
ds_read_b64_tr_b16 v[136:137], v16 offset:46208
ds_read_b64_tr_b16 v[138:139], v16 offset:46976
s_waitcnt lgkmcnt(8)
v_mfma_f32_32x32x16_bf16 v[36:51], v[120:123], v[168:171], v[36:51]
s_waitcnt lgkmcnt(0)
s_waitcnt vmcnt(12)
s_barrier
ds_read_b64_tr_b16 v[116:117], v16 offset:0
ds_read_b64_tr_b16 v[118:119], v16 offset:768
v_mfma_f32_32x32x16_bf16 v[52:67], v[124:127], v[168:171], v[52:67]
ds_read_b64_tr_b16 v[120:121], v16 offset:64
ds_read_b64_tr_b16 v[122:123], v16 offset:832
s_add_u32 m0, s30, 36864
s_nop 0
buffer_load_dwordx4 v5, s[16:19], s51 offen lds
v_mfma_f32_32x32x16_bf16 v[68:83], v[128:131], v[168:171], v[68:83]
ds_read_b64_tr_b16 v[124:125], v16 offset:128
ds_read_b64_tr_b16 v[126:127], v16 offset:896
v_mfma_f32_32x32x16_bf16 v[84:99], v[132:135], v[168:171], v[84:99]
ds_read_b64_tr_b16 v[128:129], v16 offset:6144
ds_read_b64_tr_b16 v[130:131], v16 offset:6912
s_add_u32 m0, s30, 37888
s_nop 0
buffer_load_dwordx4 v6, s[16:19], s51 offen lds
v_mfma_f32_32x32x16_bf16 v[100:115], v[136:139], v[168:171], v[100:115]
ds_read_b64_tr_b16 v[132:133], v16 offset:6208
ds_read_b64_tr_b16 v[134:135], v16 offset:6976
s_waitcnt lgkmcnt(8)
v_mfma_f32_32x32x16_bf16 v[20:35], v[116:119], v[140:143], v[20:35]
ds_read_b64_tr_b16 v[136:137], v16 offset:6272
ds_read_b64_tr_b16 v[138:139], v16 offset:7040
s_waitcnt vmcnt(12)
ds_read_b128 v[156:159], v12 offset:4096
ds_read_b128 v[160:163], v13 offset:4096
ds_read_b128 v[164:167], v14 offset:4096
ds_read_b128 v[168:171], v15 offset:4096
s_add_u32 m0, s30, 38912
s_nop 0
buffer_load_dwordx4 v7, s[16:19], s51 offen lds
s_waitcnt lgkmcnt(12)
v_mfma_f32_32x32x16_bf16 v[36:51], v[120:123], v[140:143], v[36:51]
ds_read_b64_tr_b16 v[116:117], v16 offset:3072
ds_read_b64_tr_b16 v[118:119], v16 offset:3840
s_waitcnt lgkmcnt(12)
v_mfma_f32_32x32x16_bf16 v[52:67], v[124:127], v[140:143], v[52:67]
ds_read_b64_tr_b16 v[120:121], v16 offset:3136
ds_read_b64_tr_b16 v[122:123], v16 offset:3904
s_waitcnt lgkmcnt(12)
v_mfma_f32_32x32x16_bf16 v[68:83], v[128:131], v[140:143], v[68:83]
ds_read_b64_tr_b16 v[124:125], v16 offset:3200
ds_read_b64_tr_b16 v[126:127], v16 offset:3968
s_waitcnt lgkmcnt(6)
s_add_u32 m0, s31, 4096
s_nop 0
buffer_load_dwordx4 v8, s[12:15], s63 offen lds
v_mfma_f32_32x32x16_bf16 v[84:99], v[132:135], v[140:143], v[84:99]
ds_read_b64_tr_b16 v[128:129], v16 offset:9216
ds_read_b64_tr_b16 v[130:131], v16 offset:9984
v_mfma_f32_32x32x16_bf16 v[100:115], v[136:139], v[140:143], v[100:115]
ds_read_b64_tr_b16 v[132:133], v16 offset:9280
ds_read_b64_tr_b16 v[134:135], v16 offset:10048
s_add_u32 m0, s31, 5120
s_nop 0
buffer_load_dwordx4 v9, s[12:15], s63 offen lds
s_waitcnt lgkmcnt(8)
v_mfma_f32_32x32x16_bf16 v[20:35], v[116:119], v[144:147], v[20:35]
ds_read_b64_tr_b16 v[136:137], v16 offset:9344
ds_read_b64_tr_b16 v[138:139], v16 offset:10112
s_waitcnt lgkmcnt(8)
v_mfma_f32_32x32x16_bf16 v[36:51], v[120:123], v[144:147], v[36:51]
s_waitcnt lgkmcnt(0)
s_waitcnt vmcnt(12)
s_barrier
ds_read_b64_tr_b16 v[116:117], v16 offset:12288
ds_read_b64_tr_b16 v[118:119], v16 offset:13056
v_mfma_f32_32x32x16_bf16 v[52:67], v[124:127], v[144:147], v[52:67]
ds_read_b64_tr_b16 v[120:121], v16 offset:12352
ds_read_b64_tr_b16 v[122:123], v16 offset:13120
s_add_u32 m0, s30, 0
s_nop 0
buffer_load_dwordx4 v5, s[16:19], s52 offen lds
v_mfma_f32_32x32x16_bf16 v[68:83], v[128:131], v[144:147], v[68:83]
ds_read_b64_tr_b16 v[124:125], v16 offset:12416
ds_read_b64_tr_b16 v[126:127], v16 offset:13184
v_mfma_f32_32x32x16_bf16 v[84:99], v[132:135], v[144:147], v[84:99]
ds_read_b64_tr_b16 v[128:129], v16 offset:18432
ds_read_b64_tr_b16 v[130:131], v16 offset:19200
s_add_u32 m0, s30, 1024
s_nop 0
buffer_load_dwordx4 v6, s[16:19], s52 offen lds
v_mfma_f32_32x32x16_bf16 v[100:115], v[136:139], v[144:147], v[100:115]
ds_read_b64_tr_b16 v[132:133], v16 offset:18496
ds_read_b64_tr_b16 v[134:135], v16 offset:19264
s_waitcnt lgkmcnt(8)
v_mfma_f32_32x32x16_bf16 v[20:35], v[116:119], v[148:151], v[20:35]
ds_read_b64_tr_b16 v[136:137], v16 offset:18560
ds_read_b64_tr_b16 v[138:139], v16 offset:19328
s_add_u32 m0, s30, 2048
s_nop 0
buffer_load_dwordx4 v7, s[16:19], s52 offen lds
s_waitcnt lgkmcnt(8)
v_mfma_f32_32x32x16_bf16 v[36:51], v[120:123], v[148:151], v[36:51]
ds_read_b64_tr_b16 v[116:117], v16 offset:15360
ds_read_b64_tr_b16 v[118:119], v16 offset:16128
s_waitcnt lgkmcnt(8)
v_mfma_f32_32x32x16_bf16 v[52:67], v[124:127], v[148:151], v[52:67]
ds_read_b64_tr_b16 v[120:121], v16 offset:15424
ds_read_b64_tr_b16 v[122:123], v16 offset:16192
s_waitcnt lgkmcnt(8)
v_mfma_f32_32x32x16_bf16 v[68:83], v[128:131], v[148:151], v[68:83]
ds_read_b64_tr_b16 v[124:125], v16 offset:15488
ds_read_b64_tr_b16 v[126:127], v16 offset:16256
s_add_u32 m0, s31, 6144
s_nop 0
buffer_load_dwordx4 v10, s[12:15], s63 offen lds
s_waitcnt lgkmcnt(8)
v_mfma_f32_32x32x16_bf16 v[84:99], v[132:135], v[148:151], v[84:99]
ds_read_b64_tr_b16 v[128:129], v16 offset:21504
ds_read_b64_tr_b16 v[130:131], v16 offset:22272
s_waitcnt lgkmcnt(8)
v_mfma_f32_32x32x16_bf16 v[100:115], v[136:139], v[148:151], v[100:115]
ds_read_b64_tr_b16 v[132:133], v16 offset:21568
ds_read_b64_tr_b16 v[134:135], v16 offset:22336
s_add_u32 m0, s31, 7168
s_nop 0
buffer_load_dwordx4 v11, s[12:15], s63 offen lds
s_waitcnt lgkmcnt(8)
v_mfma_f32_32x32x16_bf16 v[20:35], v[116:119], v[152:155], v[20:35]
ds_read_b64_tr_b16 v[136:137], v16 offset:21632
ds_read_b64_tr_b16 v[138:139], v16 offset:22400
s_waitcnt lgkmcnt(8)
v_mfma_f32_32x32x16_bf16 v[36:51], v[120:123], v[152:155], v[36:51]
s_waitcnt lgkmcnt(0)
s_waitcnt vmcnt(12)
s_barrier
ds_read_b64_tr_b16 v[116:117], v16 offset:24576
ds_read_b64_tr_b16 v[118:119], v16 offset:25344
v_mfma_f32_32x32x16_bf16 v[52:67], v[124:127], v[152:155], v[52:67]
ds_read_b64_tr_b16 v[120:121], v16 offset:24640
ds_read_b64_tr_b16 v[122:123], v16 offset:25408
s_add_u32 m0, s30, 12288
s_nop 0
buffer_load_dwordx4 v5, s[16:19], s53 offen lds
v_mfma_f32_32x32x16_bf16 v[68:83], v[128:131], v[152:155], v[68:83]
ds_read_b64_tr_b16 v[124:125], v16 offset:24704
ds_read_b64_tr_b16 v[126:127], v16 offset:25472
v_mfma_f32_32x32x16_bf16 v[84:99], v[132:135], v[152:155], v[84:99]
ds_read_b64_tr_b16 v[128:129], v16 offset:30720
ds_read_b64_tr_b16 v[130:131], v16 offset:31488
s_add_u32 m0, s30, 13312
s_nop 0
buffer_load_dwordx4 v6, s[16:19], s53 offen lds
v_mfma_f32_32x32x16_bf16 v[100:115], v[136:139], v[152:155], v[100:115]
ds_read_b64_tr_b16 v[132:133], v16 offset:30784
ds_read_b64_tr_b16 v[134:135], v16 offset:31552
s_waitcnt lgkmcnt(8)
v_mfma_f32_32x32x16_bf16 v[20:35], v[116:119], v[156:159], v[20:35]
ds_read_b64_tr_b16 v[136:137], v16 offset:30848
ds_read_b64_tr_b16 v[138:139], v16 offset:31616
s_waitcnt vmcnt(12)
ds_read_b128 v[140:143], v12 offset:0
ds_read_b128 v[144:147], v13 offset:0
ds_read_b128 v[148:151], v14 offset:0
ds_read_b128 v[152:155], v15 offset:0
s_add_u32 m0, s30, 14336
s_nop 0
buffer_load_dwordx4 v7, s[16:19], s53 offen lds
s_waitcnt lgkmcnt(12)
v_mfma_f32_32x32x16_bf16 v[36:51], v[120:123], v[156:159], v[36:51]
ds_read_b64_tr_b16 v[116:117], v16 offset:27648
ds_read_b64_tr_b16 v[118:119], v16 offset:28416
s_waitcnt lgkmcnt(12)
v_mfma_f32_32x32x16_bf16 v[52:67], v[124:127], v[156:159], v[52:67]
ds_read_b64_tr_b16 v[120:121], v16 offset:27712
ds_read_b64_tr_b16 v[122:123], v16 offset:28480
s_waitcnt lgkmcnt(12)
v_mfma_f32_32x32x16_bf16 v[68:83], v[128:131], v[156:159], v[68:83]
ds_read_b64_tr_b16 v[124:125], v16 offset:27776
ds_read_b64_tr_b16 v[126:127], v16 offset:28544
s_waitcnt lgkmcnt(12)
v_mfma_f32_32x32x16_bf16 v[84:99], v[132:135], v[156:159], v[84:99]
ds_read_b64_tr_b16 v[128:129], v16 offset:33792
ds_read_b64_tr_b16 v[130:131], v16 offset:34560
s_waitcnt lgkmcnt(12)
v_mfma_f32_32x32x16_bf16 v[100:115], v[136:139], v[156:159], v[100:115]
ds_read_b64_tr_b16 v[132:133], v16 offset:33856
ds_read_b64_tr_b16 v[134:135], v16 offset:34624
s_waitcnt lgkmcnt(8)
v_mfma_f32_32x32x16_bf16 v[20:35], v[116:119], v[160:163], v[20:35]
ds_read_b64_tr_b16 v[136:137], v16 offset:33920
ds_read_b64_tr_b16 v[138:139], v16 offset:34688
s_waitcnt lgkmcnt(8)
v_mfma_f32_32x32x16_bf16 v[36:51], v[120:123], v[160:163], v[36:51]
s_waitcnt lgkmcnt(0)
s_waitcnt vmcnt(10)
s_barrier
ds_read_b64_tr_b16 v[116:117], v16 offset:36864
ds_read_b64_tr_b16 v[118:119], v16 offset:37632
v_mfma_f32_32x32x16_bf16 v[52:67], v[124:127], v[160:163], v[52:67]
ds_read_b64_tr_b16 v[120:121], v16 offset:36928
ds_read_b64_tr_b16 v[122:123], v16 offset:37696
s_add_u32 m0, s30, 24576
s_nop 0
buffer_load_dwordx4 v5, s[16:19], s54 offen lds
v_mfma_f32_32x32x16_bf16 v[68:83], v[128:131], v[160:163], v[68:83]
ds_read_b64_tr_b16 v[124:125], v16 offset:36992
ds_read_b64_tr_b16 v[126:127], v16 offset:37760
v_mfma_f32_32x32x16_bf16 v[84:99], v[132:135], v[160:163], v[84:99]
ds_read_b64_tr_b16 v[128:129], v16 offset:43008
ds_read_b64_tr_b16 v[130:131], v16 offset:43776
s_add_u32 m0, s30, 25600
s_nop 0
buffer_load_dwordx4 v6, s[16:19], s54 offen lds
v_mfma_f32_32x32x16_bf16 v[100:115], v[136:139], v[160:163], v[100:115]
ds_read_b64_tr_b16 v[132:133], v16 offset:43072
ds_read_b64_tr_b16 v[134:135], v16 offset:43840
s_waitcnt lgkmcnt(8)
v_mfma_f32_32x32x16_bf16 v[20:35], v[116:119], v[164:167], v[20:35]
ds_read_b64_tr_b16 v[136:137], v16 offset:43136
ds_read_b64_tr_b16 v[138:139], v16 offset:43904
s_add_u32 m0, s30, 26624
s_nop 0
buffer_load_dwordx4 v7, s[16:19], s54 offen lds
s_waitcnt lgkmcnt(8)
v_mfma_f32_32x32x16_bf16 v[36:51], v[120:123], v[164:167], v[36:51]
ds_read_b64_tr_b16 v[116:117], v16 offset:39936
ds_read_b64_tr_b16 v[118:119], v16 offset:40704
s_waitcnt lgkmcnt(8)
v_mfma_f32_32x32x16_bf16 v[52:67], v[124:127], v[164:167], v[52:67]
ds_read_b64_tr_b16 v[120:121], v16 offset:40000
ds_read_b64_tr_b16 v[122:123], v16 offset:40768
s_waitcnt lgkmcnt(8)
v_mfma_f32_32x32x16_bf16 v[68:83], v[128:131], v[164:167], v[68:83]
ds_read_b64_tr_b16 v[124:125], v16 offset:40064
ds_read_b64_tr_b16 v[126:127], v16 offset:40832
s_waitcnt lgkmcnt(8)
v_mfma_f32_32x32x16_bf16 v[84:99], v[132:135], v[164:167], v[84:99]
ds_read_b64_tr_b16 v[128:129], v16 offset:46080
ds_read_b64_tr_b16 v[130:131], v16 offset:46848
s_waitcnt lgkmcnt(8)
v_mfma_f32_32x32x16_bf16 v[100:115], v[136:139], v[164:167], v[100:115]
ds_read_b64_tr_b16 v[132:133], v16 offset:46144
ds_read_b64_tr_b16 v[134:135], v16 offset:46912
s_waitcnt lgkmcnt(8)
v_mfma_f32_32x32x16_bf16 v[20:35], v[116:119], v[168:171], v[20:35]
ds_read_b64_tr_b16 v[136:137], v16 offset:46208
ds_read_b64_tr_b16 v[138:139], v16 offset:46976
s_waitcnt lgkmcnt(8)
v_mfma_f32_32x32x16_bf16 v[36:51], v[120:123], v[168:171], v[36:51]
s_waitcnt lgkmcnt(0)
s_waitcnt vmcnt(8)
s_barrier
ds_read_b64_tr_b16 v[116:117], v16 offset:0
ds_read_b64_tr_b16 v[118:119], v16 offset:768
v_mfma_f32_32x32x16_bf16 v[52:67], v[124:127], v[168:171], v[52:67]
ds_read_b64_tr_b16 v[120:121], v16 offset:64
ds_read_b64_tr_b16 v[122:123], v16 offset:832
s_add_u32 m0, s30, 36864
s_nop 0
buffer_load_dwordx4 v5, s[16:19], s55 offen lds
v_mfma_f32_32x32x16_bf16 v[68:83], v[128:131], v[168:171], v[68:83]
ds_read_b64_tr_b16 v[124:125], v16 offset:128
ds_read_b64_tr_b16 v[126:127], v16 offset:896
v_mfma_f32_32x32x16_bf16 v[84:99], v[132:135], v[168:171], v[84:99]
ds_read_b64_tr_b16 v[128:129], v16 offset:6144
ds_read_b64_tr_b16 v[130:131], v16 offset:6912
s_add_u32 m0, s30, 37888
s_nop 0
buffer_load_dwordx4 v6, s[16:19], s55 offen lds
v_mfma_f32_32x32x16_bf16 v[100:115], v[136:139], v[168:171], v[100:115]
ds_read_b64_tr_b16 v[132:133], v16 offset:6208
ds_read_b64_tr_b16 v[134:135], v16 offset:6976
s_waitcnt lgkmcnt(8)
v_mfma_f32_32x32x16_bf16 v[20:35], v[116:119], v[140:143], v[20:35]
ds_read_b64_tr_b16 v[136:137], v16 offset:6272
ds_read_b64_tr_b16 v[138:139], v16 offset:7040
s_waitcnt vmcnt(8)
ds_read_b128 v[156:159], v12 offset:4096
ds_read_b128 v[160:163], v13 offset:4096
ds_read_b128 v[164:167], v14 offset:4096
ds_read_b128 v[168:171], v15 offset:4096
s_add_u32 m0, s30, 38912
s_nop 0
buffer_load_dwordx4 v7, s[16:19], s55 offen lds
s_waitcnt lgkmcnt(12)
v_mfma_f32_32x32x16_bf16 v[36:51], v[120:123], v[140:143], v[36:51]
ds_read_b64_tr_b16 v[116:117], v16 offset:3072
ds_read_b64_tr_b16 v[118:119], v16 offset:3840
s_waitcnt lgkmcnt(12)
v_mfma_f32_32x32x16_bf16 v[52:67], v[124:127], v[140:143], v[52:67]
ds_read_b64_tr_b16 v[120:121], v16 offset:3136
ds_read_b64_tr_b16 v[122:123], v16 offset:3904
s_waitcnt lgkmcnt(12)
v_mfma_f32_32x32x16_bf16 v[68:83], v[128:131], v[140:143], v[68:83]
ds_read_b64_tr_b16 v[124:125], v16 offset:3200
ds_read_b64_tr_b16 v[126:127], v16 offset:3968
s_add_u32 s32, s40, 0
s_add_u32 m0, s31, 0
s_nop 0
buffer_load_dwordx4 v172, s[36:39], s32 offen lds
s_waitcnt lgkmcnt(12)
v_mfma_f32_32x32x16_bf16 v[84:99], v[132:135], v[140:143], v[84:99]
ds_read_b64_tr_b16 v[128:129], v16 offset:9216
ds_read_b64_tr_b16 v[130:131], v16 offset:9984
s_waitcnt lgkmcnt(12)
v_mfma_f32_32x32x16_bf16 v[100:115], v[136:139], v[140:143], v[100:115]
ds_read_b64_tr_b16 v[132:133], v16 offset:9280
ds_read_b64_tr_b16 v[134:135], v16 offset:10048
s_add_u32 s32, s40, 8192
s_add_u32 m0, s31, 1024
s_nop 0
buffer_load_dwordx4 v172, s[36:39], s32 offen lds
s_waitcnt lgkmcnt(8)
v_mfma_f32_32x32x16_bf16 v[20:35], v[116:119], v[144:147], v[20:35]
ds_read_b64_tr_b16 v[136:137], v16 offset:9344
ds_read_b64_tr_b16 v[138:139], v16 offset:10112
s_waitcnt lgkmcnt(8)
v_mfma_f32_32x32x16_bf16 v[36:51], v[120:123], v[144:147], v[36:51]
s_waitcnt lgkmcnt(0)
s_waitcnt vmcnt(8)
s_barrier
ds_read_b64_tr_b16 v[116:117], v16 offset:12288
ds_read_b64_tr_b16 v[118:119], v16 offset:13056
v_mfma_f32_32x32x16_bf16 v[52:67], v[124:127], v[144:147], v[52:67]
ds_read_b64_tr_b16 v[120:121], v16 offset:12352
ds_read_b64_tr_b16 v[122:123], v16 offset:13120
s_add_u32 s32, s41, 65536
s_add_u32 m0, s42, 0
s_nop 0
buffer_load_dwordx4 v172, s[36:39], s32 offen lds
v_mfma_f32_32x32x16_bf16 v[68:83], v[128:131], v[144:147], v[68:83]
ds_read_b64_tr_b16 v[124:125], v16 offset:12416
ds_read_b64_tr_b16 v[126:127], v16 offset:13184
v_mfma_f32_32x32x16_bf16 v[84:99], v[132:135], v[144:147], v[84:99]
ds_read_b64_tr_b16 v[128:129], v16 offset:18432
ds_read_b64_tr_b16 v[130:131], v16 offset:19200
s_add_u32 s32, s41, 98304
s_add_u32 m0, s42, 4096
s_nop 0
buffer_load_dwordx4 v172, s[36:39], s32 offen lds
v_mfma_f32_32x32x16_bf16 v[100:115], v[136:139], v[144:147], v[100:115]
ds_read_b64_tr_b16 v[132:133], v16 offset:18496
ds_read_b64_tr_b16 v[134:135], v16 offset:19264
s_waitcnt lgkmcnt(8)
v_mfma_f32_32x32x16_bf16 v[20:35], v[116:119], v[148:151], v[20:35]
ds_read_b64_tr_b16 v[136:137], v16 offset:18560
ds_read_b64_tr_b16 v[138:139], v16 offset:19328
s_add_u32 s32, s41, 131072
s_add_u32 m0, s42, 8192
s_nop 0
buffer_load_dwordx4 v172, s[36:39], s32 offen lds
s_waitcnt lgkmcnt(8)
v_mfma_f32_32x32x16_bf16 v[36:51], v[120:123], v[148:151], v[36:51]
ds_read_b64_tr_b16 v[116:117], v16 offset:15360
ds_read_b64_tr_b16 v[118:119], v16 offset:16128
s_waitcnt lgkmcnt(8)
v_mfma_f32_32x32x16_bf16 v[52:67], v[124:127], v[148:151], v[52:67]
ds_read_b64_tr_b16 v[120:121], v16 offset:15424
ds_read_b64_tr_b16 v[122:123], v16 offset:16192
s_waitcnt lgkmcnt(8)
v_mfma_f32_32x32x16_bf16 v[68:83], v[128:131], v[148:151], v[68:83]
ds_read_b64_tr_b16 v[124:125], v16 offset:15488
ds_read_b64_tr_b16 v[126:127], v16 offset:16256
s_add_u32 s32, s40, 16384
s_add_u32 m0, s31, 2048
s_nop 0
buffer_load_dwordx4 v172, s[36:39], s32 offen lds
s_waitcnt lgkmcnt(8)
v_mfma_f32_32x32x16_bf16 v[84:99], v[132:135], v[148:151], v[84:99]
ds_read_b64_tr_b16 v[128:129], v16 offset:21504
ds_read_b64_tr_b16 v[130:131], v16 offset:22272
s_waitcnt lgkmcnt(8)
v_mfma_f32_32x32x16_bf16 v[100:115], v[136:139], v[148:151], v[100:115]
ds_read_b64_tr_b16 v[132:133], v16 offset:21568
ds_read_b64_tr_b16 v[134:135], v16 offset:22336
s_add_u32 s32, s40, 24576
s_add_u32 m0, s31, 3072
s_nop 0
buffer_load_dwordx4 v172, s[36:39], s32 offen lds
s_waitcnt lgkmcnt(8)
v_mfma_f32_32x32x16_bf16 v[20:35], v[116:119], v[152:155], v[20:35]
ds_read_b64_tr_b16 v[136:137], v16 offset:21632
ds_read_b64_tr_b16 v[138:139], v16 offset:22400
s_waitcnt lgkmcnt(8)
v_mfma_f32_32x32x16_bf16 v[36:51], v[120:123], v[152:155], v[36:51]
s_waitcnt lgkmcnt(0)
s_waitcnt vmcnt(10)
s_barrier
ds_read_b64_tr_b16 v[116:117], v16 offset:24576
ds_read_b64_tr_b16 v[118:119], v16 offset:25344
v_mfma_f32_32x32x16_bf16 v[52:67], v[124:127], v[152:155], v[52:67]
ds_read_b64_tr_b16 v[120:121], v16 offset:24640
ds_read_b64_tr_b16 v[122:123], v16 offset:25408
s_add_u32 s32, s41, 425984
s_add_u32 m0, s42, 12288
s_nop 0
buffer_load_dwordx4 v172, s[36:39], s32 offen lds
v_mfma_f32_32x32x16_bf16 v[68:83], v[128:131], v[152:155], v[68:83]
ds_read_b64_tr_b16 v[124:125], v16 offset:24704
ds_read_b64_tr_b16 v[126:127], v16 offset:25472
v_mfma_f32_32x32x16_bf16 v[84:99], v[132:135], v[152:155], v[84:99]
ds_read_b64_tr_b16 v[128:129], v16 offset:30720
ds_read_b64_tr_b16 v[130:131], v16 offset:31488
s_add_u32 s32, s41, 458752
s_add_u32 m0, s42, 16384
s_nop 0
buffer_load_dwordx4 v172, s[36:39], s32 offen lds
v_mfma_f32_32x32x16_bf16 v[100:115], v[136:139], v[152:155], v[100:115]
ds_read_b64_tr_b16 v[132:133], v16 offset:30784
ds_read_b64_tr_b16 v[134:135], v16 offset:31552
s_waitcnt lgkmcnt(8)
v_mfma_f32_32x32x16_bf16 v[20:35], v[116:119], v[156:159], v[20:35]
ds_read_b64_tr_b16 v[136:137], v16 offset:30848
ds_read_b64_tr_b16 v[138:139], v16 offset:31616
s_add_u32 s32, s41, 491520
s_add_u32 m0, s42, 20480
s_nop 0
buffer_load_dwordx4 v172, s[36:39], s32 offen lds
s_waitcnt lgkmcnt(8)
v_mfma_f32_32x32x16_bf16 v[36:51], v[120:123], v[156:159], v[36:51]
ds_read_b64_tr_b16 v[116:117], v16 offset:27648
ds_read_b64_tr_b16 v[118:119], v16 offset:28416
s_waitcnt lgkmcnt(8)
v_mfma_f32_32x32x16_bf16 v[52:67], v[124:127], v[156:159], v[52:67]
ds_read_b64_tr_b16 v[120:121], v16 offset:27712
ds_read_b64_tr_b16 v[122:123], v16 offset:28480
s_waitcnt lgkmcnt(8)
v_mfma_f32_32x32x16_bf16 v[68:83], v[128:131], v[156:159], v[68:83]
ds_read_b64_tr_b16 v[124:125], v16 offset:27776
ds_read_b64_tr_b16 v[126:127], v16 offset:28544
s_add_u32 s32, s40, 32768
s_add_u32 m0, s31, 4096
s_nop 0
buffer_load_dwordx4 v172, s[36:39], s32 offen lds
s_waitcnt lgkmcnt(8)
v_mfma_f32_32x32x16_bf16 v[84:99], v[132:135], v[156:159], v[84:99]
ds_read_b64_tr_b16 v[128:129], v16 offset:33792
ds_read_b64_tr_b16 v[130:131], v16 offset:34560
s_waitcnt lgkmcnt(8)
v_mfma_f32_32x32x16_bf16 v[100:115], v[136:139], v[156:159], v[100:115]
ds_read_b64_tr_b16 v[132:133], v16 offset:33856
ds_read_b64_tr_b16 v[134:135], v16 offset:34624
s_add_u32 s32, s40, 40960
s_add_u32 m0, s31, 5120
s_nop 0
buffer_load_dwordx4 v172, s[36:39], s32 offen lds
s_waitcnt lgkmcnt(8)
v_mfma_f32_32x32x16_bf16 v[20:35], v[116:119], v[160:163], v[20:35]
ds_read_b64_tr_b16 v[136:137], v16 offset:33920
ds_read_b64_tr_b16 v[138:139], v16 offset:34688
s_waitcnt lgkmcnt(8)
v_mfma_f32_32x32x16_bf16 v[36:51], v[120:123], v[160:163], v[36:51]
s_waitcnt lgkmcnt(0)
s_waitcnt vmcnt(12)
s_barrier
ds_read_b64_tr_b16 v[116:117], v16 offset:36864
ds_read_b64_tr_b16 v[118:119], v16 offset:37632
v_mfma_f32_32x32x16_bf16 v[52:67], v[124:127], v[160:163], v[52:67]
ds_read_b64_tr_b16 v[120:121], v16 offset:36928
ds_read_b64_tr_b16 v[122:123], v16 offset:37696
s_add_u32 s32, s41, 786432
s_add_u32 m0, s42, 24576
s_nop 0
buffer_load_dwordx4 v172, s[36:39], s32 offen lds
v_mfma_f32_32x32x16_bf16 v[68:83], v[128:131], v[160:163], v[68:83]
ds_read_b64_tr_b16 v[124:125], v16 offset:36992
ds_read_b64_tr_b16 v[126:127], v16 offset:37760
v_mfma_f32_32x32x16_bf16 v[84:99], v[132:135], v[160:163], v[84:99]
ds_read_b64_tr_b16 v[128:129], v16 offset:43008
ds_read_b64_tr_b16 v[130:131], v16 offset:43776
s_add_u32 s32, s41, 819200
s_add_u32 m0, s42, 28672
s_nop 0
buffer_load_dwordx4 v172, s[36:39], s32 offen lds
v_mfma_f32_32x32x16_bf16 v[100:115], v[136:139], v[160:163], v[100:115]
ds_read_b64_tr_b16 v[132:133], v16 offset:43072
ds_read_b64_tr_b16 v[134:135], v16 offset:43840
s_waitcnt lgkmcnt(8)
v_mfma_f32_32x32x16_bf16 v[20:35], v[116:119], v[164:167], v[20:35]
ds_read_b64_tr_b16 v[136:137], v16 offset:43136
ds_read_b64_tr_b16 v[138:139], v16 offset:43904
s_add_u32 s32, s41, 851968
s_add_u32 m0, s42, 32768
s_nop 0
buffer_load_dwordx4 v172, s[36:39], s32 offen lds
s_waitcnt lgkmcnt(8)
v_mfma_f32_32x32x16_bf16 v[36:51], v[120:123], v[164:167], v[36:51]
ds_read_b64_tr_b16 v[116:117], v16 offset:39936
ds_read_b64_tr_b16 v[118:119], v16 offset:40704
s_waitcnt lgkmcnt(8)
v_mfma_f32_32x32x16_bf16 v[52:67], v[124:127], v[164:167], v[52:67]
ds_read_b64_tr_b16 v[120:121], v16 offset:40000
ds_read_b64_tr_b16 v[122:123], v16 offset:40768
s_waitcnt lgkmcnt(8)
v_mfma_f32_32x32x16_bf16 v[68:83], v[128:131], v[164:167], v[68:83]
ds_read_b64_tr_b16 v[124:125], v16 offset:40064
ds_read_b64_tr_b16 v[126:127], v16 offset:40832
s_add_u32 s32, s40, 49152
s_add_u32 m0, s31, 6144
s_nop 0
buffer_load_dwordx4 v172, s[36:39], s32 offen lds
s_waitcnt lgkmcnt(8)
v_mfma_f32_32x32x16_bf16 v[84:99], v[132:135], v[164:167], v[84:99]
ds_read_b64_tr_b16 v[128:129], v16 offset:46080
ds_read_b64_tr_b16 v[130:131], v16 offset:46848
s_waitcnt lgkmcnt(8)
v_mfma_f32_32x32x16_bf16 v[100:115], v[136:139], v[164:167], v[100:115]
ds_read_b64_tr_b16 v[132:133], v16 offset:46144
ds_read_b64_tr_b16 v[134:135], v16 offset:46912
s_add_u32 s32, s40, 57344
s_add_u32 m0, s31, 7168
s_nop 0
buffer_load_dwordx4 v172, s[36:39], s32 offen lds
s_waitcnt lgkmcnt(8)
v_mfma_f32_32x32x16_bf16 v[20:35], v[116:119], v[168:171], v[20:35]
ds_read_b64_tr_b16 v[136:137], v16 offset:46208
ds_read_b64_tr_b16 v[138:139], v16 offset:46976
s_waitcnt lgkmcnt(8)
v_mfma_f32_32x32x16_bf16 v[36:51], v[120:123], v[168:171], v[36:51]
s_waitcnt lgkmcnt(0)
s_barrier
v_mfma_f32_32x32x16_bf16 v[52:67], v[124:127], v[168:171], v[52:67]
s_add_u32 s32, s41, 1146880
s_add_u32 m0, s42, 36864
s_nop 0
buffer_load_dwordx4 v172, s[36:39], s32 offen lds
v_mfma_f32_32x32x16_bf16 v[68:83], v[128:131], v[168:171], v[68:83]
s_add_u32 s32, s41, 1212416
s_add_u32 m0, s42, 45056
s_nop 0
buffer_load_dwordx4 v172, s[36:39], s32 offen lds
v_mfma_f32_32x32x16_bf16 v[84:99], v[132:135], v[168:171], v[84:99]
s_add_u32 s32, s41, 1179648
s_add_u32 m0, s42, 40960
s_nop 0
buffer_load_dwordx4 v172, s[36:39], s32 offen lds
v_mfma_f32_32x32x16_bf16 v[100:115], v[136:139], v[168:171], v[100:115]
buffer_load_dword v244, off, s[72:75], 0 sc1
v_lshlrev_b32 v2, 4, v1
s_lshl_b32 s32, s25, 2
s_add_u32 s32, s32, s24
s_mul_i32 s32, s32, 86
s_mul_i32 s33, s26, 6
s_add_u32 s32, s32, s33
s_lshl_b32 s32, s32, 10
v_max_f32 v20, 0, v20
v_max_f32 v21, 0, v21
v_max_f32 v22, 0, v22
v_max_f32 v23, 0, v23
v_max_f32 v24, 0, v24
v_max_f32 v25, 0, v25
v_max_f32 v26, 0, v26
v_max_f32 v27, 0, v27
v_pk_mul_f32 v[20:21], v[20:21], v[68:69]
v_pk_mul_f32 v[22:23], v[22:23], v[70:71]
v_pk_mul_f32 v[24:25], v[24:25], v[72:73]
v_pk_mul_f32 v[26:27], v[26:27], v[74:75]
v_cvt_pk_bf16_f32 v116, v20, v21
v_cvt_pk_bf16_f32 v117, v22, v23
v_cvt_pk_bf16_f32 v118, v24, v25
v_cvt_pk_bf16_f32 v119, v26, v27
s_add_u32 s33, s32, 0
buffer_store_dwordx4 v[116:119], v2, s[20:23], s33 offen sc1
v_max_f32 v28, 0, v28
v_max_f32 v29, 0, v29
v_max_f32 v30, 0, v30
v_max_f32 v31, 0, v31
v_max_f32 v32, 0, v32
v_max_f32 v33, 0, v33
v_max_f32 v34, 0, v34
v_max_f32 v35, 0, v35
v_pk_mul_f32 v[28:29], v[28:29], v[76:77]
v_pk_mul_f32 v[30:31], v[30:31], v[78:79]
v_pk_mul_f32 v[32:33], v[32:33], v[80:81]
v_pk_mul_f32 v[34:35], v[34:35], v[82:83]
v_cvt_pk_bf16_f32 v120, v28, v29
v_cvt_pk_bf16_f32 v121, v30, v31
v_cvt_pk_bf16_f32 v122, v32, v33
v_cvt_pk_bf16_f32 v123, v34, v35
s_add_u32 s33, s32, 1024
buffer_store_dwordx4 v[120:123], v2, s[20:23], s33 offen sc1
s_cmp_eq_u32 s26, 14
s_cbranch_scc1 fz_g1done_3
v_max_f32 v36, 0, v36
v_max_f32 v37, 0, v37
v_max_f32 v38, 0, v38
v_max_f32 v39, 0, v39
v_max_f32 v40, 0, v40
v_max_f32 v41, 0, v41
v_max_f32 v42, 0, v42
v_max_f32 v43, 0, v43
v_pk_mul_f32 v[36:37], v[36:37], v[84:85]
v_pk_mul_f32 v[38:39], v[38:39], v[86:87]
v_pk_mul_f32 v[40:41], v[40:41], v[88:89]
v_pk_mul_f32 v[42:43], v[42:43], v[90:91]
v_cvt_pk_bf16_f32 v124, v36, v37
v_cvt_pk_bf16_f32 v125, v38, v39
v_cvt_pk_bf16_f32 v126, v40, v41
v_cvt_pk_bf16_f32 v127, v42, v43
s_add_u32 s33, s32, 2048
buffer_store_dwordx4 v[124:127], v2, s[20:23], s33 offen sc1
v_max_f32 v44, 0, v44
v_max_f32 v45, 0, v45
v_max_f32 v46, 0, v46
v_max_f32 v47, 0, v47
v_max_f32 v48, 0, v48
v_max_f32 v49, 0, v49
v_max_f32 v50, 0, v50
v_max_f32 v51, 0, v51
v_pk_mul_f32 v[44:45], v[44:45], v[92:93]
v_pk_mul_f32 v[46:47], v[46:47], v[94:95]
v_pk_mul_f32 v[48:49], v[48:49], v[96:97]
v_pk_mul_f32 v[50:51], v[50:51], v[98:99]
v_cvt_pk_bf16_f32 v128, v44, v45
v_cvt_pk_bf16_f32 v129, v46, v47
v_cvt_pk_bf16_f32 v130, v48, v49
v_cvt_pk_bf16_f32 v131, v50, v51
s_add_u32 s33, s32, 3072
buffer_store_dwordx4 v[128:131], v2, s[20:23], s33 offen sc1
v_max_f32 v52, 0, v52
v_max_f32 v53, 0, v53
v_max_f32 v54, 0, v54
v_max_f32 v55, 0, v55
v_max_f32 v56, 0, v56
v_max_f32 v57, 0, v57
v_max_f32 v58, 0, v58
v_max_f32 v59, 0, v59
v_pk_mul_f32 v[52:53], v[52:53], v[100:101]
v_pk_mul_f32 v[54:55], v[54:55], v[102:103]
v_pk_mul_f32 v[56:57], v[56:57], v[104:105]
v_pk_mul_f32 v[58:59], v[58:59], v[106:107]
v_cvt_pk_bf16_f32 v132, v52, v53
v_cvt_pk_bf16_f32 v133, v54, v55
v_cvt_pk_bf16_f32 v134, v56, v57
v_cvt_pk_bf16_f32 v135, v58, v59
s_add_u32 s33, s32, 4096
buffer_store_dwordx4 v[132:135], v2, s[20:23], s33 offen sc1
v_max_f32 v60, 0, v60
v_max_f32 v61, 0, v61
v_max_f32 v62, 0, v62
v_max_f32 v63, 0, v63
v_max_f32 v64, 0, v64
v_max_f32 v65, 0, v65
v_max_f32 v66, 0, v66
v_max_f32 v67, 0, v67
v_pk_mul_f32 v[60:61], v[60:61], v[108:109]
v_pk_mul_f32 v[62:63], v[62:63], v[110:111]
v_pk_mul_f32 v[64:65], v[64:65], v[112:113]
v_pk_mul_f32 v[66:67], v[66:67], v[114:115]
v_cvt_pk_bf16_f32 v136, v60, v61
v_cvt_pk_bf16_f32 v137, v62, v63
v_cvt_pk_bf16_f32 v138, v64, v65
v_cvt_pk_bf16_f32 v139, v66, v67
s_add_u32 s33, s32, 5120
buffer_store_dwordx4 v[136:139], v2, s[20:23], s33 offen sc1
fz_g1done_3:
s_lshl_b32 s32, s25, 11
s_lshl_b32 s33, s26, 7
s_add_u32 s32, s32, s33
s_add_u32 s62, s32, 32768
s_mov_b32 s63, 1
s_branch fz_g2
fz_g:
s_load_dwordx2 s[4:5], s[0:1], 0
s_load_dwordx2 s[6:7], s[0:1], 104
v_lshrrev_b32 v2, 6, v0
v_and_b32 v1, 63, v0
v_readfirstlane_b32 s20, v2
s_sub_u32 s22, s2, 496
s_lshl_b32 s22, s22, 7
s_lshl_b32 s21, s20, 5
s_add_u32 s22, s22, s21
v_lshlrev_b32 v2, 4, v1
s_waitcnt lgkmcnt(0)
s_mov_b32 s8, s4
s_mov_b32 s9, s5
s_mov_b32 s10, 2097152
s_mov_b32 s11, 0x00020000
s_mov_b32 s12, s6
s_mov_b32 s13, s7
s_mov_b32 s14, 1024
s_mov_b32 s15, 0x00020000
s_add_u32 s68, s66, 5242880
s_addc_u32 s69, s67, 0
s_mov_b32 s70, 99328
s_mov_b32 s71, 0x00020000
s_mov_b32 s74, 256
s_mov_b32 s75, 0x00020000
s_add_u32 s16, s66, 4194304
s_addc_u32 s17, s67, 0
s_mov_b32 s18, 8192
s_mov_b32 s19, 0x00020000
buffer_load_dwordx4 v[4:7], v2, s[12:15], 0 offen
s_lshl_b32 s21, s22, 10
buffer_load_dwordx4 v[16:19], v2, s[8:11], s21 offen
buffer_load_dwordx4 v[20:23], v2, s[8:11], s21 offen offset:1024
buffer_load_dwordx4 v[24:27], v2, s[8:11], s21 offen offset:2048
buffer_load_dwordx4 v[28:31], v2, s[8:11], s21 offen offset:3072
s_add_u32 s21, s21, 4096
buffer_load_dwordx4 v[32:35], v2, s[8:11], s21 offen
buffer_load_dwordx4 v[36:39], v2, s[8:11], s21 offen offset:1024
buffer_load_dwordx4 v[40:43], v2, s[8:11], s21 offen offset:2048
buffer_load_dwordx4 v[44:47], v2, s[8:11], s21 offen offset:3072
s_add_u32 s21, s21, 4096
buffer_load_dwordx4 v[48:51], v2, s[8:11], s21 offen
buffer_load_dwordx4 v[52:55], v2, s[8:11], s21 offen offset:1024
buffer_load_dwordx4 v[56:59], v2, s[8:11], s21 offen offset:2048
buffer_load_dwordx4 v[60:63], v2, s[8:11], s21 offen offset:3072
s_add_u32 s21, s21, 4096
buffer_load_dwordx4 v[64:67], v2, s[8:11], s21 offen
buffer_load_dwordx4 v[68:71], v2, s[8:11], s21 offen offset:1024
buffer_load_dwordx4 v[72:75], v2, s[8:11], s21 offen offset:2048
buffer_load_dwordx4 v[76:79], v2, s[8:11], s21 offen offset:3072
s_add_u32 s21, s21, 4096
buffer_load_dwordx4 v[80:83], v2, s[8:11], s21 offen
buffer_load_dwordx4 v[84:87], v2, s[8:11], s21 offen offset:1024
buffer_load_dwordx4 v[88:91], v2, s[8:11], s21 offen offset:2048
buffer_load_dwordx4 v[92:95], v2, s[8:11], s21 offen offset:3072
s_add_u32 s21, s21, 4096
buffer_load_dwordx4 v[96:99], v2, s[8:11], s21 offen
buffer_load_dwordx4 v[100:103], v2, s[8:11], s21 offen offset:1024
buffer_load_dwordx4 v[104:107], v2, s[8:11], s21 offen offset:2048
buffer_load_dwordx4 v[108:111], v2, s[8:11], s21 offen offset:3072
s_add_u32 s21, s21, 4096
buffer_load_dwordx4 v[112:115], v2, s[8:11], s21 offen
buffer_load_dwordx4 v[116:119], v2, s[8:11], s21 offen offset:1024
buffer_load_dwordx4 v[120:123], v2, s[8:11], s21 offen offset:2048
buffer_load_dwordx4 v[124:127], v2, s[8:11], s21 offen offset:3072
s_add_u32 s21, s21, 4096
buffer_load_dwordx4 v[128:131], v2, s[8:11], s21 offen
buffer_load_dwordx4 v[132:135], v2, s[8:11], s21 offen offset:1024
buffer_load_dwordx4 v[136:139], v2, s[8:11], s21 offen offset:2048
buffer_load_dwordx4 v[140:143], v2, s[8:11], s21 offen offset:3072
s_waitcnt vmcnt(32)
v_lshlrev_b32 v8, 16, v4
v_and_b32 v9, 0xffff0000, v4
v_lshlrev_b32 v10, 16, v5
v_and_b32 v11, 0xffff0000, v5
v_lshlrev_b32 v12, 16, v6
v_and_b32 v13, 0xffff0000, v6
v_lshlrev_b32 v14, 16, v7
v_and_b32 v15, 0xffff0000, v7
s_waitcnt vmcnt(30)
v_lshlrev_b32 v176, 16, v16
v_and_b32 v177, 0xffff0000, v16
v_lshlrev_b32 v180, 16, v20
v_and_b32 v181, 0xffff0000, v20
v_mul_f32 v176, v176, v8
v_mul_f32 v177, v177, v9
v_mul_f32 v180, v180, v8
v_mul_f32 v181, v181, v9
v_cvt_pk_bf16_f32 v178, v176, v177
v_cvt_pk_bf16_f32 v182, v180, v181
v_lshlrev_b32 v176, 16, v178
v_and_b32 v177, 0xffff0000, v178
v_lshlrev_b32 v180, 16, v182
v_and_b32 v181, 0xffff0000, v182
v_add_f32 v144, v176, v177
v_add_f32 v145, v180, v181
v_lshlrev_b32 v176, 16, v17
v_and_b32 v177, 0xffff0000, v17
v_lshlrev_b32 v180, 16, v21
v_and_b32 v181, 0xffff0000, v21
v_mul_f32 v176, v176, v10
v_mul_f32 v177, v177, v11
v_mul_f32 v180, v180, v10
v_mul_f32 v181, v181, v11
v_cvt_pk_bf16_f32 v178, v176, v177
v_cvt_pk_bf16_f32 v182, v180, v181
v_lshlrev_b32 v176, 16, v178
v_and_b32 v177, 0xffff0000, v178
v_lshlrev_b32 v180, 16, v182
v_and_b32 v181, 0xffff0000, v182
v_add_f32 v144, v144, v176
v_add_f32 v144, v144, v177
v_add_f32 v145, v145, v180
v_add_f32 v145, v145, v181
v_lshlrev_b32 v176, 16, v18
v_and_b32 v177, 0xffff0000, v18
v_lshlrev_b32 v180, 16, v22
v_and_b32 v181, 0xffff0000, v22
v_mul_f32 v176, v176, v12
v_mul_f32 v177, v177, v13
v_mul_f32 v180, v180, v12
v_mul_f32 v181, v181, v13
v_cvt_pk_bf16_f32 v178, v176, v177
v_cvt_pk_bf16_f32 v182, v180, v181
v_lshlrev_b32 v176, 16, v178
v_and_b32 v177, 0xffff0000, v178
v_lshlrev_b32 v180, 16, v182
v_and_b32 v181, 0xffff0000, v182
v_add_f32 v144, v144, v176
v_add_f32 v144, v144, v177
v_add_f32 v145, v145, v180
v_add_f32 v145, v145, v181
v_lshlrev_b32 v176, 16, v19
v_and_b32 v177, 0xffff0000, v19
v_lshlrev_b32 v180, 16, v23
v_and_b32 v181, 0xffff0000, v23
v_mul_f32 v176, v176, v14
v_mul_f32 v177, v177, v15
v_mul_f32 v180, v180, v14
v_mul_f32 v181, v181, v15
v_cvt_pk_bf16_f32 v178, v176, v177
v_cvt_pk_bf16_f32 v182, v180, v181
v_lshlrev_b32 v176, 16, v178
v_and_b32 v177, 0xffff0000, v178
v_lshlrev_b32 v180, 16, v182
v_and_b32 v181, 0xffff0000, v182
v_add_f32 v144, v144, v176
v_add_f32 v144, v144, v177
v_add_f32 v145, v145, v180
v_add_f32 v145, v145, v181
s_waitcnt vmcnt(28)
v_lshlrev_b32 v176, 16, v24
v_and_b32 v177, 0xffff0000, v24
v_lshlrev_b32 v180, 16, v28
v_and_b32 v181, 0xffff0000, v28
v_mul_f32 v176, v176, v8
v_mul_f32 v177, v177, v9
v_mul_f32 v180, v180, v8
v_mul_f32 v181, v181, v9
v_cvt_pk_bf16_f32 v178, v176, v177
v_cvt_pk_bf16_f32 v182, v180, v181
v_lshlrev_b32 v176, 16, v178
v_and_b32 v177, 0xffff0000, v178
v_lshlrev_b32 v180, 16, v182
v_and_b32 v181, 0xffff0000, v182
v_add_f32 v146, v176, v177
v_add_f32 v147, v180, v181
v_lshlrev_b32 v176, 16, v25
v_and_b32 v177, 0xffff0000, v25
v_lshlrev_b32 v180, 16, v29
v_and_b32 v181, 0xffff0000, v29
v_mul_f32 v176, v176, v10
v_mul_f32 v177, v177, v11
v_mul_f32 v180, v180, v10
v_mul_f32 v181, v181, v11
v_cvt_pk_bf16_f32 v178, v176, v177
v_cvt_pk_bf16_f32 v182, v180, v181
v_lshlrev_b32 v176, 16, v178
v_and_b32 v177, 0xffff0000, v178
v_lshlrev_b32 v180, 16, v182
v_and_b32 v181, 0xffff0000, v182
v_add_f32 v146, v146, v176
v_add_f32 v146, v146, v177
v_add_f32 v147, v147, v180
v_add_f32 v147, v147, v181
v_lshlrev_b32 v176, 16, v26
v_and_b32 v177, 0xffff0000, v26
v_lshlrev_b32 v180, 16, v30
v_and_b32 v181, 0xffff0000, v30
v_mul_f32 v176, v176, v12
v_mul_f32 v177, v177, v13
v_mul_f32 v180, v180, v12
v_mul_f32 v181, v181, v13
v_cvt_pk_bf16_f32 v178, v176, v177
v_cvt_pk_bf16_f32 v182, v180, v181
v_lshlrev_b32 v176, 16, v178
v_and_b32 v177, 0xffff0000, v178
v_lshlrev_b32 v180, 16, v182
v_and_b32 v181, 0xffff0000, v182
v_add_f32 v146, v146, v176
v_add_f32 v146, v146, v177
v_add_f32 v147, v147, v180
v_add_f32 v147, v147, v181
v_lshlrev_b32 v176, 16, v27
v_and_b32 v177, 0xffff0000, v27
v_lshlrev_b32 v180, 16, v31
v_and_b32 v181, 0xffff0000, v31
v_mul_f32 v176, v176, v14
v_mul_f32 v177, v177, v15
v_mul_f32 v180, v180, v14
v_mul_f32 v181, v181, v15
v_cvt_pk_bf16_f32 v178, v176, v177
v_cvt_pk_bf16_f32 v182, v180, v181
v_lshlrev_b32 v176, 16, v178
v_and_b32 v177, 0xffff0000, v178
v_lshlrev_b32 v180, 16, v182
v_and_b32 v181, 0xffff0000, v182
v_add_f32 v146, v146, v176
v_add_f32 v146, v146, v177
v_add_f32 v147, v147, v180
v_add_f32 v147, v147, v181
s_waitcnt vmcnt(26)
v_lshlrev_b32 v176, 16, v32
v_and_b32 v177, 0xffff0000, v32
v_lshlrev_b32 v180, 16, v36
v_and_b32 v181, 0xffff0000, v36
v_mul_f32 v176, v176, v8
v_mul_f32 v177, v177, v9
v_mul_f32 v180, v180, v8
v_mul_f32 v181, v181, v9
v_cvt_pk_bf16_f32 v178, v176, v177
v_cvt_pk_bf16_f32 v182, v180, v181
v_lshlrev_b32 v176, 16, v178
v_and_b32 v177, 0xffff0000, v178
v_lshlrev_b32 v180, 16, v182
v_and_b32 v181, 0xffff0000, v182
v_add_f32 v148, v176, v177
v_add_f32 v149, v180, v181
v_lshlrev_b32 v176, 16, v33
v_and_b32 v177, 0xffff0000, v33
v_lshlrev_b32 v180, 16, v37
v_and_b32 v181, 0xffff0000, v37
v_mul_f32 v176, v176, v10
v_mul_f32 v177, v177, v11
v_mul_f32 v180, v180, v10
v_mul_f32 v181, v181, v11
v_cvt_pk_bf16_f32 v178, v176, v177
v_cvt_pk_bf16_f32 v182, v180, v181
v_lshlrev_b32 v176, 16, v178
v_and_b32 v177, 0xffff0000, v178
v_lshlrev_b32 v180, 16, v182
v_and_b32 v181, 0xffff0000, v182
v_add_f32 v148, v148, v176
v_add_f32 v148, v148, v177
v_add_f32 v149, v149, v180
v_add_f32 v149, v149, v181
v_lshlrev_b32 v176, 16, v34
v_and_b32 v177, 0xffff0000, v34
v_lshlrev_b32 v180, 16, v38
v_and_b32 v181, 0xffff0000, v38
v_mul_f32 v176, v176, v12
v_mul_f32 v177, v177, v13
v_mul_f32 v180, v180, v12
v_mul_f32 v181, v181, v13
v_cvt_pk_bf16_f32 v178, v176, v177
v_cvt_pk_bf16_f32 v182, v180, v181
v_lshlrev_b32 v176, 16, v178
v_and_b32 v177, 0xffff0000, v178
v_lshlrev_b32 v180, 16, v182
v_and_b32 v181, 0xffff0000, v182
v_add_f32 v148, v148, v176
v_add_f32 v148, v148, v177
v_add_f32 v149, v149, v180
v_add_f32 v149, v149, v181
v_lshlrev_b32 v176, 16, v35
v_and_b32 v177, 0xffff0000, v35
v_lshlrev_b32 v180, 16, v39
v_and_b32 v181, 0xffff0000, v39
v_mul_f32 v176, v176, v14
v_mul_f32 v177, v177, v15
v_mul_f32 v180, v180, v14
v_mul_f32 v181, v181, v15
v_cvt_pk_bf16_f32 v178, v176, v177
v_cvt_pk_bf16_f32 v182, v180, v181
v_lshlrev_b32 v176, 16, v178
v_and_b32 v177, 0xffff0000, v178
v_lshlrev_b32 v180, 16, v182
v_and_b32 v181, 0xffff0000, v182
v_add_f32 v148, v148, v176
v_add_f32 v148, v148, v177
v_add_f32 v149, v149, v180
v_add_f32 v149, v149, v181
s_waitcnt vmcnt(24)
v_lshlrev_b32 v176, 16, v40
v_and_b32 v177, 0xffff0000, v40
v_lshlrev_b32 v180, 16, v44
v_and_b32 v181, 0xffff0000, v44
v_mul_f32 v176, v176, v8
v_mul_f32 v177, v177, v9
v_mul_f32 v180, v180, v8
v_mul_f32 v181, v181, v9
v_cvt_pk_bf16_f32 v178, v176, v177
v_cvt_pk_bf16_f32 v182, v180, v181
v_lshlrev_b32 v176, 16, v178
v_and_b32 v177, 0xffff0000, v178
v_lshlrev_b32 v180, 16, v182
v_and_b32 v181, 0xffff0000, v182
v_add_f32 v150, v176, v177
v_add_f32 v151, v180, v181
v_lshlrev_b32 v176, 16, v41
v_and_b32 v177, 0xffff0000, v41
v_lshlrev_b32 v180, 16, v45
v_and_b32 v181, 0xffff0000, v45
v_mul_f32 v176, v176, v10
v_mul_f32 v177, v177, v11
v_mul_f32 v180, v180, v10
v_mul_f32 v181, v181, v11
v_cvt_pk_bf16_f32 v178, v176, v177
v_cvt_pk_bf16_f32 v182, v180, v181
v_lshlrev_b32 v176, 16, v178
v_and_b32 v177, 0xffff0000, v178
v_lshlrev_b32 v180, 16, v182
v_and_b32 v181, 0xffff0000, v182
v_add_f32 v150, v150, v176
v_add_f32 v150, v150, v177
v_add_f32 v151, v151, v180
v_add_f32 v151, v151, v181
v_lshlrev_b32 v176, 16, v42
v_and_b32 v177, 0xffff0000, v42
v_lshlrev_b32 v180, 16, v46
v_and_b32 v181, 0xffff0000, v46
v_mul_f32 v176, v176, v12
v_mul_f32 v177, v177, v13
v_mul_f32 v180, v180, v12
v_mul_f32 v181, v181, v13
v_cvt_pk_bf16_f32 v178, v176, v177
v_cvt_pk_bf16_f32 v182, v180, v181
v_lshlrev_b32 v176, 16, v178
v_and_b32 v177, 0xffff0000, v178
v_lshlrev_b32 v180, 16, v182
v_and_b32 v181, 0xffff0000, v182
v_add_f32 v150, v150, v176
v_add_f32 v150, v150, v177
v_add_f32 v151, v151, v180
v_add_f32 v151, v151, v181
v_lshlrev_b32 v176, 16, v43
v_and_b32 v177, 0xffff0000, v43
v_lshlrev_b32 v180, 16, v47
v_and_b32 v181, 0xffff0000, v47
v_mul_f32 v176, v176, v14
v_mul_f32 v177, v177, v15
v_mul_f32 v180, v180, v14
v_mul_f32 v181, v181, v15
v_cvt_pk_bf16_f32 v178, v176, v177
v_cvt_pk_bf16_f32 v182, v180, v181
v_lshlrev_b32 v176, 16, v178
v_and_b32 v177, 0xffff0000, v178
v_lshlrev_b32 v180, 16, v182
v_and_b32 v181, 0xffff0000, v182
v_add_f32 v150, v150, v176
v_add_f32 v150, v150, v177
v_add_f32 v151, v151, v180
v_add_f32 v151, v151, v181
s_waitcnt vmcnt(22)
v_lshlrev_b32 v176, 16, v48
v_and_b32 v177, 0xffff0000, v48
v_lshlrev_b32 v180, 16, v52
v_and_b32 v181, 0xffff0000, v52
v_mul_f32 v176, v176, v8
v_mul_f32 v177, v177, v9
v_mul_f32 v180, v180, v8
v_mul_f32 v181, v181, v9
v_cvt_pk_bf16_f32 v178, v176, v177
v_cvt_pk_bf16_f32 v182, v180, v181
v_lshlrev_b32 v176, 16, v178
v_and_b32 v177, 0xffff0000, v178
v_lshlrev_b32 v180, 16, v182
v_and_b32 v181, 0xffff0000, v182
v_add_f32 v152, v176, v177
v_add_f32 v153, v180, v181
v_lshlrev_b32 v176, 16, v49
v_and_b32 v177, 0xffff0000, v49
v_lshlrev_b32 v180, 16, v53
v_and_b32 v181, 0xffff0000, v53
v_mul_f32 v176, v176, v10
v_mul_f32 v177, v177, v11
v_mul_f32 v180, v180, v10
v_mul_f32 v181, v181, v11
v_cvt_pk_bf16_f32 v178, v176, v177
v_cvt_pk_bf16_f32 v182, v180, v181
v_lshlrev_b32 v176, 16, v178
v_and_b32 v177, 0xffff0000, v178
v_lshlrev_b32 v180, 16, v182
v_and_b32 v181, 0xffff0000, v182
v_add_f32 v152, v152, v176
v_add_f32 v152, v152, v177
v_add_f32 v153, v153, v180
v_add_f32 v153, v153, v181
v_lshlrev_b32 v176, 16, v50
v_and_b32 v177, 0xffff0000, v50
v_lshlrev_b32 v180, 16, v54
v_and_b32 v181, 0xffff0000, v54
v_mul_f32 v176, v176, v12
v_mul_f32 v177, v177, v13
v_mul_f32 v180, v180, v12
v_mul_f32 v181, v181, v13
v_cvt_pk_bf16_f32 v178, v176, v177
v_cvt_pk_bf16_f32 v182, v180, v181
v_lshlrev_b32 v176, 16, v178
v_and_b32 v177, 0xffff0000, v178
v_lshlrev_b32 v180, 16, v182
v_and_b32 v181, 0xffff0000, v182
v_add_f32 v152, v152, v176
v_add_f32 v152, v152, v177
v_add_f32 v153, v153, v180
v_add_f32 v153, v153, v181
v_lshlrev_b32 v176, 16, v51
v_and_b32 v177, 0xffff0000, v51
v_lshlrev_b32 v180, 16, v55
v_and_b32 v181, 0xffff0000, v55
v_mul_f32 v176, v176, v14
v_mul_f32 v177, v177, v15
v_mul_f32 v180, v180, v14
v_mul_f32 v181, v181, v15
v_cvt_pk_bf16_f32 v178, v176, v177
v_cvt_pk_bf16_f32 v182, v180, v181
v_lshlrev_b32 v176, 16, v178
v_and_b32 v177, 0xffff0000, v178
v_lshlrev_b32 v180, 16, v182
v_and_b32 v181, 0xffff0000, v182
v_add_f32 v152, v152, v176
v_add_f32 v152, v152, v177
v_add_f32 v153, v153, v180
v_add_f32 v153, v153, v181
s_waitcnt vmcnt(20)
v_lshlrev_b32 v176, 16, v56
v_and_b32 v177, 0xffff0000, v56
v_lshlrev_b32 v180, 16, v60
v_and_b32 v181, 0xffff0000, v60
v_mul_f32 v176, v176, v8
v_mul_f32 v177, v177, v9
v_mul_f32 v180, v180, v8
v_mul_f32 v181, v181, v9
v_cvt_pk_bf16_f32 v178, v176, v177
v_cvt_pk_bf16_f32 v182, v180, v181
v_lshlrev_b32 v176, 16, v178
v_and_b32 v177, 0xffff0000, v178
v_lshlrev_b32 v180, 16, v182
v_and_b32 v181, 0xffff0000, v182
v_add_f32 v154, v176, v177
v_add_f32 v155, v180, v181
v_lshlrev_b32 v176, 16, v57
v_and_b32 v177, 0xffff0000, v57
v_lshlrev_b32 v180, 16, v61
v_and_b32 v181, 0xffff0000, v61
v_mul_f32 v176, v176, v10
v_mul_f32 v177, v177, v11
v_mul_f32 v180, v180, v10
v_mul_f32 v181, v181, v11
v_cvt_pk_bf16_f32 v178, v176, v177
v_cvt_pk_bf16_f32 v182, v180, v181
v_lshlrev_b32 v176, 16, v178
v_and_b32 v177, 0xffff0000, v178
v_lshlrev_b32 v180, 16, v182
v_and_b32 v181, 0xffff0000, v182
v_add_f32 v154, v154, v176
v_add_f32 v154, v154, v177
v_add_f32 v155, v155, v180
v_add_f32 v155, v155, v181
v_lshlrev_b32 v176, 16, v58
v_and_b32 v177, 0xffff0000, v58
v_lshlrev_b32 v180, 16, v62
v_and_b32 v181, 0xffff0000, v62
v_mul_f32 v176, v176, v12
v_mul_f32 v177, v177, v13
v_mul_f32 v180, v180, v12
v_mul_f32 v181, v181, v13
v_cvt_pk_bf16_f32 v178, v176, v177
v_cvt_pk_bf16_f32 v182, v180, v181
v_lshlrev_b32 v176, 16, v178
v_and_b32 v177, 0xffff0000, v178
v_lshlrev_b32 v180, 16, v182
v_and_b32 v181, 0xffff0000, v182
v_add_f32 v154, v154, v176
v_add_f32 v154, v154, v177
v_add_f32 v155, v155, v180
v_add_f32 v155, v155, v181
v_lshlrev_b32 v176, 16, v59
v_and_b32 v177, 0xffff0000, v59
v_lshlrev_b32 v180, 16, v63
v_and_b32 v181, 0xffff0000, v63
v_mul_f32 v176, v176, v14
v_mul_f32 v177, v177, v15
v_mul_f32 v180, v180, v14
v_mul_f32 v181, v181, v15
v_cvt_pk_bf16_f32 v178, v176, v177
v_cvt_pk_bf16_f32 v182, v180, v181
v_lshlrev_b32 v176, 16, v178
v_and_b32 v177, 0xffff0000, v178
v_lshlrev_b32 v180, 16, v182
v_and_b32 v181, 0xffff0000, v182
v_add_f32 v154, v154, v176
v_add_f32 v154, v154, v177
v_add_f32 v155, v155, v180
v_add_f32 v155, v155, v181
s_waitcnt vmcnt(18)
v_lshlrev_b32 v176, 16, v64
v_and_b32 v177, 0xffff0000, v64
v_lshlrev_b32 v180, 16, v68
v_and_b32 v181, 0xffff0000, v68
v_mul_f32 v176, v176, v8
v_mul_f32 v177, v177, v9
v_mul_f32 v180, v180, v8
v_mul_f32 v181, v181, v9
v_cvt_pk_bf16_f32 v178, v176, v177
v_cvt_pk_bf16_f32 v182, v180, v181
v_lshlrev_b32 v176, 16, v178
v_and_b32 v177, 0xffff0000, v178
v_lshlrev_b32 v180, 16, v182
v_and_b32 v181, 0xffff0000, v182
v_add_f32 v156, v176, v177
v_add_f32 v157, v180, v181
v_lshlrev_b32 v176, 16, v65
v_and_b32 v177, 0xffff0000, v65
v_lshlrev_b32 v180, 16, v69
v_and_b32 v181, 0xffff0000, v69
v_mul_f32 v176, v176, v10
v_mul_f32 v177, v177, v11
v_mul_f32 v180, v180, v10
v_mul_f32 v181, v181, v11
v_cvt_pk_bf16_f32 v178, v176, v177
v_cvt_pk_bf16_f32 v182, v180, v181
v_lshlrev_b32 v176, 16, v178
v_and_b32 v177, 0xffff0000, v178
v_lshlrev_b32 v180, 16, v182
v_and_b32 v181, 0xffff0000, v182
v_add_f32 v156, v156, v176
v_add_f32 v156, v156, v177
v_add_f32 v157, v157, v180
v_add_f32 v157, v157, v181
v_lshlrev_b32 v176, 16, v66
v_and_b32 v177, 0xffff0000, v66
v_lshlrev_b32 v180, 16, v70
v_and_b32 v181, 0xffff0000, v70
v_mul_f32 v176, v176, v12
v_mul_f32 v177, v177, v13
v_mul_f32 v180, v180, v12
v_mul_f32 v181, v181, v13
v_cvt_pk_bf16_f32 v178, v176, v177
v_cvt_pk_bf16_f32 v182, v180, v181
v_lshlrev_b32 v176, 16, v178
v_and_b32 v177, 0xffff0000, v178
v_lshlrev_b32 v180, 16, v182
v_and_b32 v181, 0xffff0000, v182
v_add_f32 v156, v156, v176
v_add_f32 v156, v156, v177
v_add_f32 v157, v157, v180
v_add_f32 v157, v157, v181
v_lshlrev_b32 v176, 16, v67
v_and_b32 v177, 0xffff0000, v67
v_lshlrev_b32 v180, 16, v71
v_and_b32 v181, 0xffff0000, v71
v_mul_f32 v176, v176, v14
v_mul_f32 v177, v177, v15
v_mul_f32 v180, v180, v14
v_mul_f32 v181, v181, v15
v_cvt_pk_bf16_f32 v178, v176, v177
v_cvt_pk_bf16_f32 v182, v180, v181
v_lshlrev_b32 v176, 16, v178
v_and_b32 v177, 0xffff0000, v178
v_lshlrev_b32 v180, 16, v182
v_and_b32 v181, 0xffff0000, v182
v_add_f32 v156, v156, v176
v_add_f32 v156, v156, v177
v_add_f32 v157, v157, v180
v_add_f32 v157, v157, v181
s_waitcnt vmcnt(16)
v_lshlrev_b32 v176, 16, v72
v_and_b32 v177, 0xffff0000, v72
v_lshlrev_b32 v180, 16, v76
v_and_b32 v181, 0xffff0000, v76
v_mul_f32 v176, v176, v8
v_mul_f32 v177, v177, v9
v_mul_f32 v180, v180, v8
v_mul_f32 v181, v181, v9
v_cvt_pk_bf16_f32 v178, v176, v177
v_cvt_pk_bf16_f32 v182, v180, v181
v_lshlrev_b32 v176, 16, v178
v_and_b32 v177, 0xffff0000, v178
v_lshlrev_b32 v180, 16, v182
v_and_b32 v181, 0xffff0000, v182
v_add_f32 v158, v176, v177
v_add_f32 v159, v180, v181
v_lshlrev_b32 v176, 16, v73
v_and_b32 v177, 0xffff0000, v73
v_lshlrev_b32 v180, 16, v77
v_and_b32 v181, 0xffff0000, v77
v_mul_f32 v176, v176, v10
v_mul_f32 v177, v177, v11
v_mul_f32 v180, v180, v10
v_mul_f32 v181, v181, v11
v_cvt_pk_bf16_f32 v178, v176, v177
v_cvt_pk_bf16_f32 v182, v180, v181
v_lshlrev_b32 v176, 16, v178
v_and_b32 v177, 0xffff0000, v178
v_lshlrev_b32 v180, 16, v182
v_and_b32 v181, 0xffff0000, v182
v_add_f32 v158, v158, v176
v_add_f32 v158, v158, v177
v_add_f32 v159, v159, v180
v_add_f32 v159, v159, v181
v_lshlrev_b32 v176, 16, v74
v_and_b32 v177, 0xffff0000, v74
v_lshlrev_b32 v180, 16, v78
v_and_b32 v181, 0xffff0000, v78
v_mul_f32 v176, v176, v12
v_mul_f32 v177, v177, v13
v_mul_f32 v180, v180, v12
v_mul_f32 v181, v181, v13
v_cvt_pk_bf16_f32 v178, v176, v177
v_cvt_pk_bf16_f32 v182, v180, v181
v_lshlrev_b32 v176, 16, v178
v_and_b32 v177, 0xffff0000, v178
v_lshlrev_b32 v180, 16, v182
v_and_b32 v181, 0xffff0000, v182
v_add_f32 v158, v158, v176
v_add_f32 v158, v158, v177
v_add_f32 v159, v159, v180
v_add_f32 v159, v159, v181
v_lshlrev_b32 v176, 16, v75
v_and_b32 v177, 0xffff0000, v75
v_lshlrev_b32 v180, 16, v79
v_and_b32 v181, 0xffff0000, v79
v_mul_f32 v176, v176, v14
v_mul_f32 v177, v177, v15
v_mul_f32 v180, v180, v14
v_mul_f32 v181, v181, v15
v_cvt_pk_bf16_f32 v178, v176, v177
v_cvt_pk_bf16_f32 v182, v180, v181
v_lshlrev_b32 v176, 16, v178
v_and_b32 v177, 0xffff0000, v178
v_lshlrev_b32 v180, 16, v182
v_and_b32 v181, 0xffff0000, v182
v_add_f32 v158, v158, v176
v_add_f32 v158, v158, v177
v_add_f32 v159, v159, v180
v_add_f32 v159, v159, v181
s_waitcnt vmcnt(14)
v_lshlrev_b32 v176, 16, v80
v_and_b32 v177, 0xffff0000, v80
v_lshlrev_b32 v180, 16, v84
v_and_b32 v181, 0xffff0000, v84
v_mul_f32 v176, v176, v8
v_mul_f32 v177, v177, v9
v_mul_f32 v180, v180, v8
v_mul_f32 v181, v181, v9
v_cvt_pk_bf16_f32 v178, v176, v177
v_cvt_pk_bf16_f32 v182, v180, v181
v_lshlrev_b32 v176, 16, v178
v_and_b32 v177, 0xffff0000, v178
v_lshlrev_b32 v180, 16, v182
v_and_b32 v181, 0xffff0000, v182
v_add_f32 v160, v176, v177
v_add_f32 v161, v180, v181
v_lshlrev_b32 v176, 16, v81
v_and_b32 v177, 0xffff0000, v81
v_lshlrev_b32 v180, 16, v85
v_and_b32 v181, 0xffff0000, v85
v_mul_f32 v176, v176, v10
v_mul_f32 v177, v177, v11
v_mul_f32 v180, v180, v10
v_mul_f32 v181, v181, v11
v_cvt_pk_bf16_f32 v178, v176, v177
v_cvt_pk_bf16_f32 v182, v180, v181
v_lshlrev_b32 v176, 16, v178
v_and_b32 v177, 0xffff0000, v178
v_lshlrev_b32 v180, 16, v182
v_and_b32 v181, 0xffff0000, v182
v_add_f32 v160, v160, v176
v_add_f32 v160, v160, v177
v_add_f32 v161, v161, v180
v_add_f32 v161, v161, v181
v_lshlrev_b32 v176, 16, v82
v_and_b32 v177, 0xffff0000, v82
v_lshlrev_b32 v180, 16, v86
v_and_b32 v181, 0xffff0000, v86
v_mul_f32 v176, v176, v12
v_mul_f32 v177, v177, v13
v_mul_f32 v180, v180, v12
v_mul_f32 v181, v181, v13
v_cvt_pk_bf16_f32 v178, v176, v177
v_cvt_pk_bf16_f32 v182, v180, v181
v_lshlrev_b32 v176, 16, v178
v_and_b32 v177, 0xffff0000, v178
v_lshlrev_b32 v180, 16, v182
v_and_b32 v181, 0xffff0000, v182
v_add_f32 v160, v160, v176
v_add_f32 v160, v160, v177
v_add_f32 v161, v161, v180
v_add_f32 v161, v161, v181
v_lshlrev_b32 v176, 16, v83
v_and_b32 v177, 0xffff0000, v83
v_lshlrev_b32 v180, 16, v87
v_and_b32 v181, 0xffff0000, v87
v_mul_f32 v176, v176, v14
v_mul_f32 v177, v177, v15
v_mul_f32 v180, v180, v14
v_mul_f32 v181, v181, v15
v_cvt_pk_bf16_f32 v178, v176, v177
v_cvt_pk_bf16_f32 v182, v180, v181
v_lshlrev_b32 v176, 16, v178
v_and_b32 v177, 0xffff0000, v178
v_lshlrev_b32 v180, 16, v182
v_and_b32 v181, 0xffff0000, v182
v_add_f32 v160, v160, v176
v_add_f32 v160, v160, v177
v_add_f32 v161, v161, v180
v_add_f32 v161, v161, v181
s_waitcnt vmcnt(12)
v_lshlrev_b32 v176, 16, v88
v_and_b32 v177, 0xffff0000, v88
v_lshlrev_b32 v180, 16, v92
v_and_b32 v181, 0xffff0000, v92
v_mul_f32 v176, v176, v8
v_mul_f32 v177, v177, v9
v_mul_f32 v180, v180, v8
v_mul_f32 v181, v181, v9
v_cvt_pk_bf16_f32 v178, v176, v177
v_cvt_pk_bf16_f32 v182, v180, v181
v_lshlrev_b32 v176, 16, v178
v_and_b32 v177, 0xffff0000, v178
v_lshlrev_b32 v180, 16, v182
v_and_b32 v181, 0xffff0000, v182
v_add_f32 v162, v176, v177
v_add_f32 v163, v180, v181
v_lshlrev_b32 v176, 16, v89
v_and_b32 v177, 0xffff0000, v89
v_lshlrev_b32 v180, 16, v93
v_and_b32 v181, 0xffff0000, v93
v_mul_f32 v176, v176, v10
v_mul_f32 v177, v177, v11
v_mul_f32 v180, v180, v10
v_mul_f32 v181, v181, v11
v_cvt_pk_bf16_f32 v178, v176, v177
v_cvt_pk_bf16_f32 v182, v180, v181
v_lshlrev_b32 v176, 16, v178
v_and_b32 v177, 0xffff0000, v178
v_lshlrev_b32 v180, 16, v182
v_and_b32 v181, 0xffff0000, v182
v_add_f32 v162, v162, v176
v_add_f32 v162, v162, v177
v_add_f32 v163, v163, v180
v_add_f32 v163, v163, v181
v_lshlrev_b32 v176, 16, v90
v_and_b32 v177, 0xffff0000, v90
v_lshlrev_b32 v180, 16, v94
v_and_b32 v181, 0xffff0000, v94
v_mul_f32 v176, v176, v12
v_mul_f32 v177, v177, v13
v_mul_f32 v180, v180, v12
v_mul_f32 v181, v181, v13
v_cvt_pk_bf16_f32 v178, v176, v177
v_cvt_pk_bf16_f32 v182, v180, v181
v_lshlrev_b32 v176, 16, v178
v_and_b32 v177, 0xffff0000, v178
v_lshlrev_b32 v180, 16, v182
v_and_b32 v181, 0xffff0000, v182
v_add_f32 v162, v162, v176
v_add_f32 v162, v162, v177
v_add_f32 v163, v163, v180
v_add_f32 v163, v163, v181
v_lshlrev_b32 v176, 16, v91
v_and_b32 v177, 0xffff0000, v91
v_lshlrev_b32 v180, 16, v95
v_and_b32 v181, 0xffff0000, v95
v_mul_f32 v176, v176, v14
v_mul_f32 v177, v177, v15
v_mul_f32 v180, v180, v14
v_mul_f32 v181, v181, v15
v_cvt_pk_bf16_f32 v178, v176, v177
v_cvt_pk_bf16_f32 v182, v180, v181
v_lshlrev_b32 v176, 16, v178
v_and_b32 v177, 0xffff0000, v178
v_lshlrev_b32 v180, 16, v182
v_and_b32 v181, 0xffff0000, v182
v_add_f32 v162, v162, v176
v_add_f32 v162, v162, v177
v_add_f32 v163, v163, v180
v_add_f32 v163, v163, v181
s_waitcnt vmcnt(10)
v_lshlrev_b32 v176, 16, v96
v_and_b32 v177, 0xffff0000, v96
v_lshlrev_b32 v180, 16, v100
v_and_b32 v181, 0xffff0000, v100
v_mul_f32 v176, v176, v8
v_mul_f32 v177, v177, v9
v_mul_f32 v180, v180, v8
v_mul_f32 v181, v181, v9
v_cvt_pk_bf16_f32 v178, v176, v177
v_cvt_pk_bf16_f32 v182, v180, v181
v_lshlrev_b32 v176, 16, v178
v_and_b32 v177, 0xffff0000, v178
v_lshlrev_b32 v180, 16, v182
v_and_b32 v181, 0xffff0000, v182
v_add_f32 v164, v176, v177
v_add_f32 v165, v180, v181
v_lshlrev_b32 v176, 16, v97
v_and_b32 v177, 0xffff0000, v97
v_lshlrev_b32 v180, 16, v101
v_and_b32 v181, 0xffff0000, v101
v_mul_f32 v176, v176, v10
v_mul_f32 v177, v177, v11
v_mul_f32 v180, v180, v10
v_mul_f32 v181, v181, v11
v_cvt_pk_bf16_f32 v178, v176, v177
v_cvt_pk_bf16_f32 v182, v180, v181
v_lshlrev_b32 v176, 16, v178
v_and_b32 v177, 0xffff0000, v178
v_lshlrev_b32 v180, 16, v182
v_and_b32 v181, 0xffff0000, v182
v_add_f32 v164, v164, v176
v_add_f32 v164, v164, v177
v_add_f32 v165, v165, v180
v_add_f32 v165, v165, v181
v_lshlrev_b32 v176, 16, v98
v_and_b32 v177, 0xffff0000, v98
v_lshlrev_b32 v180, 16, v102
v_and_b32 v181, 0xffff0000, v102
v_mul_f32 v176, v176, v12
v_mul_f32 v177, v177, v13
v_mul_f32 v180, v180, v12
v_mul_f32 v181, v181, v13
v_cvt_pk_bf16_f32 v178, v176, v177
v_cvt_pk_bf16_f32 v182, v180, v181
v_lshlrev_b32 v176, 16, v178
v_and_b32 v177, 0xffff0000, v178
v_lshlrev_b32 v180, 16, v182
v_and_b32 v181, 0xffff0000, v182
v_add_f32 v164, v164, v176
v_add_f32 v164, v164, v177
v_add_f32 v165, v165, v180
v_add_f32 v165, v165, v181
v_lshlrev_b32 v176, 16, v99
v_and_b32 v177, 0xffff0000, v99
v_lshlrev_b32 v180, 16, v103
v_and_b32 v181, 0xffff0000, v103
v_mul_f32 v176, v176, v14
v_mul_f32 v177, v177, v15
v_mul_f32 v180, v180, v14
v_mul_f32 v181, v181, v15
v_cvt_pk_bf16_f32 v178, v176, v177
v_cvt_pk_bf16_f32 v182, v180, v181
v_lshlrev_b32 v176, 16, v178
v_and_b32 v177, 0xffff0000, v178
v_lshlrev_b32 v180, 16, v182
v_and_b32 v181, 0xffff0000, v182
v_add_f32 v164, v164, v176
v_add_f32 v164, v164, v177
v_add_f32 v165, v165, v180
v_add_f32 v165, v165, v181
s_waitcnt vmcnt(8)
v_lshlrev_b32 v176, 16, v104
v_and_b32 v177, 0xffff0000, v104
v_lshlrev_b32 v180, 16, v108
v_and_b32 v181, 0xffff0000, v108
v_mul_f32 v176, v176, v8
v_mul_f32 v177, v177, v9
v_mul_f32 v180, v180, v8
v_mul_f32 v181, v181, v9
v_cvt_pk_bf16_f32 v178, v176, v177
v_cvt_pk_bf16_f32 v182, v180, v181
v_lshlrev_b32 v176, 16, v178
v_and_b32 v177, 0xffff0000, v178
v_lshlrev_b32 v180, 16, v182
v_and_b32 v181, 0xffff0000, v182
v_add_f32 v166, v176, v177
v_add_f32 v167, v180, v181
v_lshlrev_b32 v176, 16, v105
v_and_b32 v177, 0xffff0000, v105
v_lshlrev_b32 v180, 16, v109
v_and_b32 v181, 0xffff0000, v109
v_mul_f32 v176, v176, v10
v_mul_f32 v177, v177, v11
v_mul_f32 v180, v180, v10
v_mul_f32 v181, v181, v11
v_cvt_pk_bf16_f32 v178, v176, v177
v_cvt_pk_bf16_f32 v182, v180, v181
v_lshlrev_b32 v176, 16, v178
v_and_b32 v177, 0xffff0000, v178
v_lshlrev_b32 v180, 16, v182
v_and_b32 v181, 0xffff0000, v182
v_add_f32 v166, v166, v176
v_add_f32 v166, v166, v177
v_add_f32 v167, v167, v180
v_add_f32 v167, v167, v181
v_lshlrev_b32 v176, 16, v106
v_and_b32 v177, 0xffff0000, v106
v_lshlrev_b32 v180, 16, v110
v_and_b32 v181, 0xffff0000, v110
v_mul_f32 v176, v176, v12
v_mul_f32 v177, v177, v13
v_mul_f32 v180, v180, v12
v_mul_f32 v181, v181, v13
v_cvt_pk_bf16_f32 v178, v176, v177
v_cvt_pk_bf16_f32 v182, v180, v181
v_lshlrev_b32 v176, 16, v178
v_and_b32 v177, 0xffff0000, v178
v_lshlrev_b32 v180, 16, v182
v_and_b32 v181, 0xffff0000, v182
v_add_f32 v166, v166, v176
v_add_f32 v166, v166, v177
v_add_f32 v167, v167, v180
v_add_f32 v167, v167, v181
v_lshlrev_b32 v176, 16, v107
v_and_b32 v177, 0xffff0000, v107
v_lshlrev_b32 v180, 16, v111
v_and_b32 v181, 0xffff0000, v111
v_mul_f32 v176, v176, v14
v_mul_f32 v177, v177, v15
v_mul_f32 v180, v180, v14
v_mul_f32 v181, v181, v15
v_cvt_pk_bf16_f32 v178, v176, v177
v_cvt_pk_bf16_f32 v182, v180, v181
v_lshlrev_b32 v176, 16, v178
v_and_b32 v177, 0xffff0000, v178
v_lshlrev_b32 v180, 16, v182
v_and_b32 v181, 0xffff0000, v182
v_add_f32 v166, v166, v176
v_add_f32 v166, v166, v177
v_add_f32 v167, v167, v180
v_add_f32 v167, v167, v181
s_waitcnt vmcnt(6)
v_lshlrev_b32 v176, 16, v112
v_and_b32 v177, 0xffff0000, v112
v_lshlrev_b32 v180, 16, v116
v_and_b32 v181, 0xffff0000, v116
v_mul_f32 v176, v176, v8
v_mul_f32 v177, v177, v9
v_mul_f32 v180, v180, v8
v_mul_f32 v181, v181, v9
v_cvt_pk_bf16_f32 v178, v176, v177
v_cvt_pk_bf16_f32 v182, v180, v181
v_lshlrev_b32 v176, 16, v178
v_and_b32 v177, 0xffff0000, v178
v_lshlrev_b32 v180, 16, v182
v_and_b32 v181, 0xffff0000, v182
v_add_f32 v168, v176, v177
v_add_f32 v169, v180, v181
v_lshlrev_b32 v176, 16, v113
v_and_b32 v177, 0xffff0000, v113
v_lshlrev_b32 v180, 16, v117
v_and_b32 v181, 0xffff0000, v117
v_mul_f32 v176, v176, v10
v_mul_f32 v177, v177, v11
v_mul_f32 v180, v180, v10
v_mul_f32 v181, v181, v11
v_cvt_pk_bf16_f32 v178, v176, v177
v_cvt_pk_bf16_f32 v182, v180, v181
v_lshlrev_b32 v176, 16, v178
v_and_b32 v177, 0xffff0000, v178
v_lshlrev_b32 v180, 16, v182
v_and_b32 v181, 0xffff0000, v182
v_add_f32 v168, v168, v176
v_add_f32 v168, v168, v177
v_add_f32 v169, v169, v180
v_add_f32 v169, v169, v181
v_lshlrev_b32 v176, 16, v114
v_and_b32 v177, 0xffff0000, v114
v_lshlrev_b32 v180, 16, v118
v_and_b32 v181, 0xffff0000, v118
v_mul_f32 v176, v176, v12
v_mul_f32 v177, v177, v13
v_mul_f32 v180, v180, v12
v_mul_f32 v181, v181, v13
v_cvt_pk_bf16_f32 v178, v176, v177
v_cvt_pk_bf16_f32 v182, v180, v181
v_lshlrev_b32 v176, 16, v178
v_and_b32 v177, 0xffff0000, v178
v_lshlrev_b32 v180, 16, v182
v_and_b32 v181, 0xffff0000, v182
v_add_f32 v168, v168, v176
v_add_f32 v168, v168, v177
v_add_f32 v169, v169, v180
v_add_f32 v169, v169, v181
v_lshlrev_b32 v176, 16, v115
v_and_b32 v177, 0xffff0000, v115
v_lshlrev_b32 v180, 16, v119
v_and_b32 v181, 0xffff0000, v119
v_mul_f32 v176, v176, v14
v_mul_f32 v177, v177, v15
v_mul_f32 v180, v180, v14
v_mul_f32 v181, v181, v15
v_cvt_pk_bf16_f32 v178, v176, v177
v_cvt_pk_bf16_f32 v182, v180, v181
v_lshlrev_b32 v176, 16, v178
v_and_b32 v177, 0xffff0000, v178
v_lshlrev_b32 v180, 16, v182
v_and_b32 v181, 0xffff0000, v182
v_add_f32 v168, v168, v176
v_add_f32 v168, v168, v177
v_add_f32 v169, v169, v180
v_add_f32 v169, v169, v181
s_waitcnt vmcnt(4)
v_lshlrev_b32 v176, 16, v120
v_and_b32 v177, 0xffff0000, v120
v_lshlrev_b32 v180, 16, v124
v_and_b32 v181, 0xffff0000, v124
v_mul_f32 v176, v176, v8
v_mul_f32 v177, v177, v9
v_mul_f32 v180, v180, v8
v_mul_f32 v181, v181, v9
v_cvt_pk_bf16_f32 v178, v176, v177
v_cvt_pk_bf16_f32 v182, v180, v181
v_lshlrev_b32 v176, 16, v178
v_and_b32 v177, 0xffff0000, v178
v_lshlrev_b32 v180, 16, v182
v_and_b32 v181, 0xffff0000, v182
v_add_f32 v170, v176, v177
v_add_f32 v171, v180, v181
v_lshlrev_b32 v176, 16, v121
v_and_b32 v177, 0xffff0000, v121
v_lshlrev_b32 v180, 16, v125
v_and_b32 v181, 0xffff0000, v125
v_mul_f32 v176, v176, v10
v_mul_f32 v177, v177, v11
v_mul_f32 v180, v180, v10
v_mul_f32 v181, v181, v11
v_cvt_pk_bf16_f32 v178, v176, v177
v_cvt_pk_bf16_f32 v182, v180, v181
v_lshlrev_b32 v176, 16, v178
v_and_b32 v177, 0xffff0000, v178
v_lshlrev_b32 v180, 16, v182
v_and_b32 v181, 0xffff0000, v182
v_add_f32 v170, v170, v176
v_add_f32 v170, v170, v177
v_add_f32 v171, v171, v180
v_add_f32 v171, v171, v181
v_lshlrev_b32 v176, 16, v122
v_and_b32 v177, 0xffff0000, v122
v_lshlrev_b32 v180, 16, v126
v_and_b32 v181, 0xffff0000, v126
v_mul_f32 v176, v176, v12
v_mul_f32 v177, v177, v13
v_mul_f32 v180, v180, v12
v_mul_f32 v181, v181, v13
v_cvt_pk_bf16_f32 v178, v176, v177
v_cvt_pk_bf16_f32 v182, v180, v181
v_lshlrev_b32 v176, 16, v178
v_and_b32 v177, 0xffff0000, v178
v_lshlrev_b32 v180, 16, v182
v_and_b32 v181, 0xffff0000, v182
v_add_f32 v170, v170, v176
v_add_f32 v170, v170, v177
v_add_f32 v171, v171, v180
v_add_f32 v171, v171, v181
v_lshlrev_b32 v176, 16, v123
v_and_b32 v177, 0xffff0000, v123
v_lshlrev_b32 v180, 16, v127
v_and_b32 v181, 0xffff0000, v127
v_mul_f32 v176, v176, v14
v_mul_f32 v177, v177, v15
v_mul_f32 v180, v180, v14
v_mul_f32 v181, v181, v15
v_cvt_pk_bf16_f32 v178, v176, v177
v_cvt_pk_bf16_f32 v182, v180, v181
v_lshlrev_b32 v176, 16, v178
v_and_b32 v177, 0xffff0000, v178
v_lshlrev_b32 v180, 16, v182
v_and_b32 v181, 0xffff0000, v182
v_add_f32 v170, v170, v176
v_add_f32 v170, v170, v177
v_add_f32 v171, v171, v180
v_add_f32 v171, v171, v181
s_waitcnt vmcnt(2)
v_lshlrev_b32 v176, 16, v128
v_and_b32 v177, 0xffff0000, v128
v_lshlrev_b32 v180, 16, v132
v_and_b32 v181, 0xffff0000, v132
v_mul_f32 v176, v176, v8
v_mul_f32 v177, v177, v9
v_mul_f32 v180, v180, v8
v_mul_f32 v181, v181, v9
v_cvt_pk_bf16_f32 v178, v176, v177
v_cvt_pk_bf16_f32 v182, v180, v181
v_lshlrev_b32 v176, 16, v178
v_and_b32 v177, 0xffff0000, v178
v_lshlrev_b32 v180, 16, v182
v_and_b32 v181, 0xffff0000, v182
v_add_f32 v172, v176, v177
v_add_f32 v173, v180, v181
v_lshlrev_b32 v176, 16, v129
v_and_b32 v177, 0xffff0000, v129
v_lshlrev_b32 v180, 16, v133
v_and_b32 v181, 0xffff0000, v133
v_mul_f32 v176, v176, v10
v_mul_f32 v177, v177, v11
v_mul_f32 v180, v180, v10
v_mul_f32 v181, v181, v11
v_cvt_pk_bf16_f32 v178, v176, v177
v_cvt_pk_bf16_f32 v182, v180, v181
v_lshlrev_b32 v176, 16, v178
v_and_b32 v177, 0xffff0000, v178
v_lshlrev_b32 v180, 16, v182
v_and_b32 v181, 0xffff0000, v182
v_add_f32 v172, v172, v176
v_add_f32 v172, v172, v177
v_add_f32 v173, v173, v180
v_add_f32 v173, v173, v181
v_lshlrev_b32 v176, 16, v130
v_and_b32 v177, 0xffff0000, v130
v_lshlrev_b32 v180, 16, v134
v_and_b32 v181, 0xffff0000, v134
v_mul_f32 v176, v176, v12
v_mul_f32 v177, v177, v13
v_mul_f32 v180, v180, v12
v_mul_f32 v181, v181, v13
v_cvt_pk_bf16_f32 v178, v176, v177
v_cvt_pk_bf16_f32 v182, v180, v181
v_lshlrev_b32 v176, 16, v178
v_and_b32 v177, 0xffff0000, v178
v_lshlrev_b32 v180, 16, v182
v_and_b32 v181, 0xffff0000, v182
v_add_f32 v172, v172, v176
v_add_f32 v172, v172, v177
v_add_f32 v173, v173, v180
v_add_f32 v173, v173, v181
v_lshlrev_b32 v176, 16, v131
v_and_b32 v177, 0xffff0000, v131
v_lshlrev_b32 v180, 16, v135
v_and_b32 v181, 0xffff0000, v135
v_mul_f32 v176, v176, v14
v_mul_f32 v177, v177, v15
v_mul_f32 v180, v180, v14
v_mul_f32 v181, v181, v15
v_cvt_pk_bf16_f32 v178, v176, v177
v_cvt_pk_bf16_f32 v182, v180, v181
v_lshlrev_b32 v176, 16, v178
v_and_b32 v177, 0xffff0000, v178
v_lshlrev_b32 v180, 16, v182
v_and_b32 v181, 0xffff0000, v182
v_add_f32 v172, v172, v176
v_add_f32 v172, v172, v177
v_add_f32 v173, v173, v180
v_add_f32 v173, v173, v181
s_waitcnt vmcnt(0)
v_lshlrev_b32 v176, 16, v136
v_and_b32 v177, 0xffff0000, v136
v_lshlrev_b32 v180, 16, v140
v_and_b32 v181, 0xffff0000, v140
v_mul_f32 v176, v176, v8
v_mul_f32 v177, v177, v9
v_mul_f32 v180, v180, v8
v_mul_f32 v181, v181, v9
v_cvt_pk_bf16_f32 v178, v176, v177
v_cvt_pk_bf16_f32 v182, v180, v181
v_lshlrev_b32 v176, 16, v178
v_and_b32 v177, 0xffff0000, v178
v_lshlrev_b32 v180, 16, v182
v_and_b32 v181, 0xffff0000, v182
v_add_f32 v174, v176, v177
v_add_f32 v175, v180, v181
v_lshlrev_b32 v176, 16, v137
v_and_b32 v177, 0xffff0000, v137
v_lshlrev_b32 v180, 16, v141
v_and_b32 v181, 0xffff0000, v141
v_mul_f32 v176, v176, v10
v_mul_f32 v177, v177, v11
v_mul_f32 v180, v180, v10
v_mul_f32 v181, v181, v11
v_cvt_pk_bf16_f32 v178, v176, v177
v_cvt_pk_bf16_f32 v182, v180, v181
v_lshlrev_b32 v176, 16, v178
v_and_b32 v177, 0xffff0000, v178
v_lshlrev_b32 v180, 16, v182
v_and_b32 v181, 0xffff0000, v182
v_add_f32 v174, v174, v176
v_add_f32 v174, v174, v177
v_add_f32 v175, v175, v180
v_add_f32 v175, v175, v181
v_lshlrev_b32 v176, 16, v138
v_and_b32 v177, 0xffff0000, v138
v_lshlrev_b32 v180, 16, v142
v_and_b32 v181, 0xffff0000, v142
v_mul_f32 v176, v176, v12
v_mul_f32 v177, v177, v13
v_mul_f32 v180, v180, v12
v_mul_f32 v181, v181, v13
v_cvt_pk_bf16_f32 v178, v176, v177
v_cvt_pk_bf16_f32 v182, v180, v181
v_lshlrev_b32 v176, 16, v178
v_and_b32 v177, 0xffff0000, v178
v_lshlrev_b32 v180, 16, v182
v_and_b32 v181, 0xffff0000, v182
v_add_f32 v174, v174, v176
v_add_f32 v174, v174, v177
v_add_f32 v175, v175, v180
v_add_f32 v175, v175, v181
v_lshlrev_b32 v176, 16, v139
v_and_b32 v177, 0xffff0000, v139
v_lshlrev_b32 v180, 16, v143
v_and_b32 v181, 0xffff0000, v143
v_mul_f32 v176, v176, v14
v_mul_f32 v177, v177, v15
v_mul_f32 v180, v180, v14
v_mul_f32 v181, v181, v15
v_cvt_pk_bf16_f32 v178, v176, v177
v_cvt_pk_bf16_f32 v182, v180, v181
v_lshlrev_b32 v176, 16, v178
v_and_b32 v177, 0xffff0000, v178
v_lshlrev_b32 v180, 16, v182
v_and_b32 v181, 0xffff0000, v182
v_add_f32 v174, v174, v176
v_add_f32 v174, v174, v177
v_add_f32 v175, v175, v180
v_add_f32 v175, v175, v181
buffer_load_dword v244, off, s[72:75], 0 sc1
v_permlane32_swap_b32 v144, v160
v_permlane32_swap_b32 v145, v161
v_permlane32_swap_b32 v146, v162
v_permlane32_swap_b32 v147, v163
v_permlane32_swap_b32 v148, v164
v_permlane32_swap_b32 v149, v165
v_permlane32_swap_b32 v150, v166
v_permlane32_swap_b32 v151, v167
v_permlane32_swap_b32 v152, v168
v_permlane32_swap_b32 v153, v169
v_permlane32_swap_b32 v154, v170
v_permlane32_swap_b32 v155, v171
v_permlane32_swap_b32 v156, v172
v_permlane32_swap_b32 v157, v173
v_permlane32_swap_b32 v158, v174
v_permlane32_swap_b32 v159, v175
v_add_f32 v144, v144, v160
v_add_f32 v145, v145, v161
v_add_f32 v146, v146, v162
v_add_f32 v147, v147, v163
v_add_f32 v148, v148, v164
v_add_f32 v149, v149, v165
v_add_f32 v150, v150, v166
v_add_f32 v151, v151, v167
v_add_f32 v152, v152, v168
v_add_f32 v153, v153, v169
v_add_f32 v154, v154, v170
v_add_f32 v155, v155, v171
v_add_f32 v156, v156, v172
v_add_f32 v157, v157, v173
v_add_f32 v158, v158, v174
v_add_f32 v159, v159, v175
v_permlane16_swap_b32 v144, v152
v_permlane16_swap_b32 v145, v153
v_permlane16_swap_b32 v146, v154
v_permlane16_swap_b32 v147, v155
v_permlane16_swap_b32 v148, v156
v_permlane16_swap_b32 v149, v157
v_permlane16_swap_b32 v150, v158
v_permlane16_swap_b32 v151, v159
v_add_f32 v144, v144, v152
v_add_f32 v145, v145, v153
v_add_f32 v146, v146, v154
v_add_f32 v147, v147, v155
v_add_f32 v148, v148, v156
v_add_f32 v149, v149, v157
v_add_f32 v150, v150, v158
v_add_f32 v151, v151, v159
v_add_f32_dpp v144, v144, v144 row_ror:8 row_mask:0xf bank_mask:0xf
v_add_f32_dpp v145, v145, v145 row_ror:8 row_mask:0xf bank_mask:0xf
v_add_f32_dpp v146, v146, v146 row_ror:8 row_mask:0xf bank_mask:0xf
v_add_f32_dpp v147, v147, v147 row_ror:8 row_mask:0xf bank_mask:0xf
v_add_f32_dpp v148, v148, v148 row_ror:8 row_mask:0xf bank_mask:0xf
v_add_f32_dpp v149, v149, v149 row_ror:8 row_mask:0xf bank_mask:0xf
v_add_f32_dpp v150, v150, v150 row_ror:8 row_mask:0xf bank_mask:0xf
v_add_f32_dpp v151, v151, v151 row_ror:8 row_mask:0xf bank_mask:0xf
v_add_f32_dpp v144, v144, v144 row_ror:4 row_mask:0xf bank_mask:0xf
v_add_f32_dpp v145, v145, v145 row_ror:4 row_mask:0xf bank_mask:0xf
v_add_f32_dpp v146, v146, v146 row_ror:4 row_mask:0xf bank_mask:0xf
v_add_f32_dpp v147, v147, v147 row_ror:4 row_mask:0xf bank_mask:0xf
v_add_f32_dpp v148, v148, v148 row_ror:4 row_mask:0xf bank_mask:0xf
v_add_f32_dpp v149, v149, v149 row_ror:4 row_mask:0xf bank_mask:0xf
v_add_f32_dpp v150, v150, v150 row_ror:4 row_mask:0xf bank_mask:0xf
v_add_f32_dpp v151, v151, v151 row_ror:4 row_mask:0xf bank_mask:0xf
v_add_f32_dpp v144, v144, v144 row_ror:2 row_mask:0xf bank_mask:0xf
v_add_f32_dpp v145, v145, v145 row_ror:2 row_mask:0xf bank_mask:0xf
v_add_f32_dpp v146, v146, v146 row_ror:2 row_mask:0xf bank_mask:0xf
v_add_f32_dpp v147, v147, v147 row_ror:2 row_mask:0xf bank_mask:0xf
v_add_f32_dpp v148, v148, v148 row_ror:2 row_mask:0xf bank_mask:0xf
v_add_f32_dpp v149, v149, v149 row_ror:2 row_mask:0xf bank_mask:0xf
v_add_f32_dpp v150, v150, v150 row_ror:2 row_mask:0xf bank_mask:0xf
v_add_f32_dpp v151, v151, v151 row_ror:2 row_mask:0xf bank_mask:0xf
v_add_f32_dpp v144, v144, v144 row_ror:1 row_mask:0xf bank_mask:0xf
v_add_f32_dpp v145, v145, v145 row_ror:1 row_mask:0xf bank_mask:0xf
v_add_f32_dpp v146, v146, v146 row_ror:1 row_mask:0xf bank_mask:0xf
v_add_f32_dpp v147, v147, v147 row_ror:1 row_mask:0xf bank_mask:0xf
v_add_f32_dpp v148, v148, v148 row_ror:1 row_mask:0xf bank_mask:0xf
v_add_f32_dpp v149, v149, v149 row_ror:1 row_mask:0xf bank_mask:0xf
v_add_f32_dpp v150, v150, v150 row_ror:1 row_mask:0xf bank_mask:0xf
v_add_f32_dpp v151, v151, v151 row_ror:1 row_mask:0xf bank_mask:0xf
v_and_b32 v176, 7, v1
v_cmp_eq_u32 vcc, 1, v176
s_nop 1
v_cndmask_b32 v144, v144, v145, vcc
v_cmp_eq_u32 vcc, 2, v176
s_nop 1
v_cndmask_b32 v144, v144, v146, vcc
v_cmp_eq_u32 vcc, 3, v176
s_nop 1
v_cndmask_b32 v144, v144, v147, vcc
v_cmp_eq_u32 vcc, 4, v176
s_nop 1
v_cndmask_b32 v144, v144, v148, vcc
v_cmp_eq_u32 vcc, 5, v176
s_nop 1
v_cndmask_b32 v144, v144, v149, vcc
v_cmp_eq_u32 vcc, 6, v176
s_nop 1
v_cndmask_b32 v144, v144, v150, vcc
v_cmp_eq_u32 vcc, 7, v176
s_nop 1
v_cndmask_b32 v144, v144, v151, vcc
v_cvt_pk_bf16_f32 v144, v144, v144
v_lshlrev_b32 v144, 16, v144
v_mul_f32 v144, 0xbfb8aa3b, v144
v_exp_f32 v144, v144
s_nop 0
v_add_f32 v144, 1.0, v144
v_rcp_f32 v144, v144
s_nop 0
v_cvt_pk_bf16_f32 v144, v144, v144
v_lshlrev_b32 v144, 16, v144
v_lshrrev_b32 v177, 4, v1
v_lshl_add_u32 v176, v177, 3, v176
v_lshlrev_b32 v176, 2, v176
v_and_b32 v177, 8, v1
v_cmp_eq_u32 vcc, 0, v177
s_lshl_b32 s21, s22, 2
s_and_saveexec_b64 s[24:25], vcc
buffer_store_dword v144, v176, s[16:19], s21 offen sc1
s_mov_b64 exec, s[24:25]
s_sub_u32 s21, s2, 496
s_lshl_b32 s21, s21, 11
s_add_u32 s62, s21, 34688
s_mov_b32 s63, 0
fz_g2:
s_load_dwordx2 s[4:5], s[0:1], 96
s_load_dwordx2 s[6:7], s[0:1], 112
s_load_dwordx2 s[8:9], s[0:1], 128
v_lshrrev_b32 v233, 6, v0
v_and_b32 v240, 63, v0
v_readfirstlane_b32 s24, v233
s_and_b32 s27, s2, 7
s_lshr_b32 s28, s2, 3
s_lshl_b32 s25, s27, 2
s_and_b32 s27, s28, 3
s_add_u32 s25, s25, s27
s_lshr_b32 s26, s28, 2
s_add_u32 s26, s26, 4
s_and_b32 s26, s26, 7
s_mul_i32 s31, s24, 360448
s_lshl_b32 s27, s26, 7
s_add_u32 s31, s31, s27
s_lshl_b32 s32, s24, 13
s_add_u32 s32, s32, 49152
s_mul_i32 s33, s24, 12288
v_lshrrev_b32 v233, 3, v240
v_bfe_u32 v234, v240, 4, 1
v_lshlrev_b32 v234, 2, v234
v_and_b32 v235, 7, v240
v_xor_b32 v234, v234, v235
v_lshlrev_b32 v236, 10, v233
v_lshl_add_u32 v236, v234, 4, v236
v_add_u32 v237, 8192, v236
v_add_u32 v238, 16384, v236
v_add_u32 v239, 24576, v236
s_waitcnt lgkmcnt(0)
s_mov_b32 s12, s4
s_mov_b32 s13, s5
s_mov_b32 s14, 1409024
s_mov_b32 s15, 0x00020000
s_mov_b32 s16, s8
s_mov_b32 s17, s9
s_mov_b32 s18, 33554432
s_mov_b32 s19, 0x00020000
s_mov_b32 s20, s6
s_mov_b32 s21, s7
s_mov_b32 s22, 2097152
s_mov_b32 s23, 0x00020000
v_lshrrev_b32 v233, 5, v240
v_bfe_u32 v234, v240, 2, 2
v_lshl_add_u32 v233, v233, 2, v234
v_lshlrev_b32 v233, 7, v233
v_bfe_u32 v234, v240, 3, 1
v_lshl_add_u32 v233, v234, 6, v233
v_bfe_u32 v234, v240, 4, 1
v_lshl_add_u32 v233, v234, 5, v233
v_and_b32 v234, 3, v240
v_lshl_add_u32 v233, v234, 3, v233
v_add_u32 v229, s32, v233
v_xor_b32 v230, 64, v229
v_add_u32 v231, s33, v233
v_xor_b32 v232, 64, v231
v_lshlrev_b32 v228, 4, v240
s_mul_i32 s27, s24, 22
s_mul_i32 s29, s25, 172
s_add_u32 s29, s29, s27
s_lshl_b32 s29, s29, 10
s_add_u32 s29, s29, 8388608
s_add_u32 s30, s29, 88064
s_cmp_eq_u32 s24, 3
s_cselect_b32 s34, 0, 2048
v_and_b32 v233, 31, v240
v_lshrrev_b32 v234, 5, v240
v_lshlrev_b32 v242, 14, v234
v_lshl_add_u32 v242, v233, 1, v242
v_lshlrev_b32 v241, 2, v233
s_lshl_b32 s35, s25, 6
s_lshr_b32 s27, s24, 1
s_lshl_b32 s27, s27, 5
s_add_u32 s35, s35, s27
s_mov_b32 s37, s35
s_lshl_b32 s35, s35, 1
s_lshl_b32 s27, s26, 18
s_add_u32 s35, s35, s27
s_add_u32 s35, s35, 16777216
s_and_b32 s27, s24, 1
s_lshl_b32 s27, s27, 17
s_add_u32 s35, s35, s27
s_waitcnt vmcnt(0)
v_readfirstlane_b32 s64, v244
s_nop 0
s_cmp_lg_u32 s64, 0
s_cbranch_scc1 fz_ng_4
s_mov_b32 s65, 0
fz_nl_5:
s_sleep 1
buffer_load_dword v244, off, s[72:75], 0 sc1
s_add_u32 s65, s65, 1
s_waitcnt vmcnt(0)
v_readfirstlane_b32 s64, v244
s_nop 0
s_cmp_lg_u32 s64, 0
s_cbranch_scc1 fz_ng_4
s_cmp_lt_u32 s65, 4096
s_cbranch_scc1 fz_nl_5
fz_ng_4:
s_barrier
s_cmp_lg_u32 s24, 0
s_cbranch_scc1 fz_fl_6
v_mov_b32 v244, s64
s_mov_b64 exec, 1
buffer_store_dword v244, off, s[68:71], s62 sc1
s_mov_b64 exec, -1
fz_fl_6:
s_setprio 0
s_cmp_lg_u32 s63, 0
s_cbranch_scc1 fz_g2pre_7
s_add_u32 m0, s32, 0
s_nop 0
buffer_load_dwordx4 v236, s[12:15], s31 offen lds
s_add_u32 m0, s32, 1024
s_nop 0
buffer_load_dwordx4 v237, s[12:15], s31 offen lds
s_add_u32 m0, s32, 2048
s_nop 0
buffer_load_dwordx4 v238, s[12:15], s31 offen lds
s_add_u32 m0, s32, 3072
s_nop 0
buffer_load_dwordx4 v239, s[12:15], s31 offen lds
s_add_u32 s31, s31, 32768
s_add_u32 m0, s32, 4096
s_nop 0
buffer_load_dwordx4 v236, s[12:15], s31 offen lds
s_add_u32 m0, s32, 5120
s_nop 0
buffer_load_dwordx4 v237, s[12:15], s31 offen lds
s_add_u32 m0, s32, 6144
s_nop 0
buffer_load_dwordx4 v238, s[12:15], s31 offen lds
s_add_u32 m0, s32, 7168
s_nop 0
buffer_load_dwordx4 v239, s[12:15], s31 offen lds
s_add_u32 s31, s31, 32768
s_add_u32 m0, s33, 0
s_nop 0
buffer_load_dwordx4 v236, s[12:15], s31 offen lds
s_add_u32 m0, s33, 1024
s_nop 0
buffer_load_dwordx4 v237, s[12:15], s31 offen lds
s_add_u32 m0, s33, 2048
s_nop 0
buffer_load_dwordx4 v238, s[12:15], s31 offen lds
s_add_u32 m0, s33, 3072
s_nop 0
buffer_load_dwordx4 v239, s[12:15], s31 offen lds
s_add_u32 s31, s31, 32768
s_add_u32 m0, s33, 4096
s_nop 0
buffer_load_dwordx4 v236, s[12:15], s31 offen lds
s_add_u32 m0, s33, 5120
s_nop 0
buffer_load_dwordx4 v237, s[12:15], s31 offen lds
s_add_u32 m0, s33, 6144
s_nop 0
buffer_load_dwordx4 v238, s[12:15], s31 offen lds
s_add_u32 m0, s33, 7168
s_nop 0
buffer_load_dwordx4 v239, s[12:15], s31 offen lds
s_add_u32 s31, s31, 32768
s_add_u32 m0, s33, 8192
s_nop 0
buffer_load_dwordx4 v236, s[12:15], s31 offen lds
s_add_u32 m0, s33, 9216
s_nop 0
buffer_load_dwordx4 v237, s[12:15], s31 offen lds
s_add_u32 m0, s33, 10240
s_nop 0
buffer_load_dwordx4 v238, s[12:15], s31 offen lds
s_add_u32 m0, s33, 11264
s_nop 0
buffer_load_dwordx4 v239, s[12:15], s31 offen lds
s_add_u32 s31, s31, 32768
s_branch fz_g2pd_8
fz_g2pre_7:
s_add_u32 s31, s31, 163840
fz_g2pd_8:
s_waitcnt vmcnt(16)
ds_read_b64_tr_b16 v[68:69], v229 offset:0
ds_read_b64_tr_b16 v[70:71], v229 offset:1024
ds_read_b64_tr_b16 v[72:73], v230 offset:0
ds_read_b64_tr_b16 v[74:75], v230 offset:1024
ds_read_b64_tr_b16 v[76:77], v229 offset:2048
ds_read_b64_tr_b16 v[78:79], v229 offset:3072
ds_read_b64_tr_b16 v[80:81], v230 offset:2048
ds_read_b64_tr_b16 v[82:83], v230 offset:3072
s_waitcnt lgkmcnt(0)
s_add_u32 m0, s32, 0
s_nop 0
buffer_load_dwordx4 v236, s[12:15], s31 offen lds
s_add_u32 m0, s32, 1024
s_nop 0
buffer_load_dwordx4 v237, s[12:15], s31 offen lds
s_add_u32 m0, s32, 2048
s_nop 0
buffer_load_dwordx4 v238, s[12:15], s31 offen lds
s_add_u32 m0, s32, 3072
s_nop 0
buffer_load_dwordx4 v239, s[12:15], s31 offen lds
s_add_u32 s31, s31, 32768
s_waitcnt vmcnt(16)
ds_read_b64_tr_b16 v[84:85], v229 offset:4096
ds_read_b64_tr_b16 v[86:87], v229 offset:5120
ds_read_b64_tr_b16 v[88:89], v230 offset:4096
ds_read_b64_tr_b16 v[90:91], v230 offset:5120
ds_read_b64_tr_b16 v[92:93], v229 offset:6144
ds_read_b64_tr_b16 v[94:95], v229 offset:7168
ds_read_b64_tr_b16 v[96:97], v230 offset:6144
ds_read_b64_tr_b16 v[98:99], v230 offset:7168
s_waitcnt lgkmcnt(0)
s_add_u32 m0, s32, 4096
s_nop 0
buffer_load_dwordx4 v236, s[12:15], s31 offen lds
s_add_u32 m0, s32, 5120
s_nop 0
buffer_load_dwordx4 v237, s[12:15], s31 offen lds
s_add_u32 m0, s32, 6144
s_nop 0
buffer_load_dwordx4 v238, s[12:15], s31 offen lds
s_add_u32 m0, s32, 7168
s_nop 0
buffer_load_dwordx4 v239, s[12:15], s31 offen lds
s_add_u32 s31, s31, 32768
s_waitcnt vmcnt(16)
ds_read_b64_tr_b16 v[100:101], v231 offset:0
ds_read_b64_tr_b16 v[102:103], v231 offset:1024
ds_read_b64_tr_b16 v[104:105], v232 offset:0
ds_read_b64_tr_b16 v[106:107], v232 offset:1024
ds_read_b64_tr_b16 v[108:109], v231 offset:2048
ds_read_b64_tr_b16 v[110:111], v231 offset:3072
ds_read_b64_tr_b16 v[112:113], v232 offset:2048
ds_read_b64_tr_b16 v[114:115], v232 offset:3072
s_waitcnt lgkmcnt(0)
s_add_u32 m0, s33, 0
s_nop 0
buffer_load_dwordx4 v236, s[12:15], s31 offen lds
s_add_u32 m0, s33, 1024
s_nop 0
buffer_load_dwordx4 v237, s[12:15], s31 offen lds
s_add_u32 m0, s33, 2048
s_nop 0
buffer_load_dwordx4 v238, s[12:15], s31 offen lds
s_add_u32 m0, s33, 3072
s_nop 0
buffer_load_dwordx4 v239, s[12:15], s31 offen lds
s_add_u32 s31, s31, 32768
s_waitcnt vmcnt(16)
ds_read_b64_tr_b16 v[116:117], v231 offset:4096
ds_read_b64_tr_b16 v[118:119], v231 offset:5120
ds_read_b64_tr_b16 v[120:121], v232 offset:4096
ds_read_b64_tr_b16 v[122:123], v232 offset:5120
ds_read_b64_tr_b16 v[124:125], v231 offset:6144
ds_read_b64_tr_b16 v[126:127], v231 offset:7168
ds_read_b64_tr_b16 v[128:129], v232 offset:6144
ds_read_b64_tr_b16 v[130:131], v232 offset:7168
s_waitcnt lgkmcnt(0)
s_add_u32 m0, s33, 4096
s_nop 0
buffer_load_dwordx4 v236, s[12:15], s31 offen lds
s_add_u32 m0, s33, 5120
s_nop 0
buffer_load_dwordx4 v237, s[12:15], s31 offen lds
s_add_u32 m0, s33, 6144
s_nop 0
buffer_load_dwordx4 v238, s[12:15], s31 offen lds
s_add_u32 m0, s33, 7168
s_nop 0
buffer_load_dwordx4 v239, s[12:15], s31 offen lds
s_add_u32 s31, s31, 32768
s_waitcnt vmcnt(16)
ds_read_b64_tr_b16 v[132:133], v231 offset:8192
ds_read_b64_tr_b16 v[134:135], v231 offset:9216
ds_read_b64_tr_b16 v[136:137], v232 offset:8192
ds_read_b64_tr_b16 v[138:139], v232 offset:9216
ds_read_b64_tr_b16 v[140:141], v231 offset:10240
ds_read_b64_tr_b16 v[142:143], v231 offset:11264
ds_read_b64_tr_b16 v[144:145], v232 offset:10240
ds_read_b64_tr_b16 v[146:147], v232 offset:11264
s_waitcnt lgkmcnt(0)
s_add_u32 m0, s33, 8192
s_nop 0
buffer_load_dwordx4 v236, s[12:15], s31 offen lds
s_add_u32 m0, s33, 9216
s_nop 0
buffer_load_dwordx4 v237, s[12:15], s31 offen lds
s_add_u32 m0, s33, 10240
s_nop 0
buffer_load_dwordx4 v238, s[12:15], s31 offen lds
s_add_u32 m0, s33, 11264
s_nop 0
buffer_load_dwordx4 v239, s[12:15], s31 offen lds
s_add_u32 s31, s31, 32768
s_waitcnt vmcnt(16)
ds_read_b64_tr_b16 v[148:149], v229 offset:0
ds_read_b64_tr_b16 v[150:151], v229 offset:1024
ds_read_b64_tr_b16 v[152:153], v230 offset:0
ds_read_b64_tr_b16 v[154:155], v230 offset:1024
ds_read_b64_tr_b16 v[156:157], v229 offset:2048
ds_read_b64_tr_b16 v[158:159], v229 offset:3072
ds_read_b64_tr_b16 v[160:161], v230 offset:2048
ds_read_b64_tr_b16 v[162:163], v230 offset:3072
s_waitcnt lgkmcnt(0)
s_add_u32 m0, s32, 0
s_nop 0
buffer_load_dwordx4 v236, s[12:15], s31 offen lds
s_add_u32 m0, s32, 1024
s_nop 0
buffer_load_dwordx4 v237, s[12:15], s31 offen lds
s_add_u32 m0, s32, 2048
s_nop 0
buffer_load_dwordx4 v238, s[12:15], s31 offen lds
s_add_u32 m0, s32, 3072
s_nop 0
buffer_load_dwordx4 v239, s[12:15], s31 offen lds
s_add_u32 s31, s31, 32768
s_cmp_lg_u32 s24, 0
s_cbranch_scc1 fz_sh_9
s_lshr_b32 s27, s25, 1
s_lshl_b32 s27, s27, 11
s_add_u32 s27, s27, 32768
v_and_b32 v233, 15, v240
v_lshlrev_b32 v233, 7, v233
s_mov_b32 s65, 0
fz_sl_11:
buffer_load_dword v243, v233, s[68:71], s27 offen sc1
s_add_u32 s65, s65, 1
s_waitcnt vmcnt(0)
v_cmp_ne_u32 vcc, s64, v243
s_nop 0
s_cbranch_vccz fz_sd_10
s_sleep 1
s_cmp_lt_u32 s65, 4096
s_cbranch_scc1 fz_sl_11
fz_sd_10:
fz_sh_9:
s_barrier
s_setprio 3
buffer_load_dwordx4 v[164:167], v228, s[16:19], s29 offen offset:0 sc1
buffer_load_dwordx4 v[168:171], v228, s[16:19], s30 offen offset:0 sc1
buffer_load_dwordx4 v[172:175], v228, s[16:19], s29 offen offset:1024 sc1
buffer_load_dwordx4 v[176:179], v228, s[16:19], s30 offen offset:1024 sc1
s_add_u32 s29, s29, 2048
s_add_u32 s30, s30, 2048
buffer_load_dwordx4 v[180:183], v228, s[16:19], s29 offen offset:0 sc1
buffer_load_dwordx4 v[184:187], v228, s[16:19], s30 offen offset:0 sc1
buffer_load_dwordx4 v[188:191], v228, s[16:19], s29 offen offset:1024 sc1
buffer_load_dwordx4 v[192:195], v228, s[16:19], s30 offen offset:1024 sc1
s_add_u32 s29, s29, 2048
s_add_u32 s30, s30, 2048
buffer_load_dwordx4 v[196:199], v228, s[16:19], s29 offen offset:0 sc1
buffer_load_dwordx4 v[200:203], v228, s[16:19], s30 offen offset:0 sc1
buffer_load_dwordx4 v[204:207], v228, s[16:19], s29 offen offset:1024 sc1
buffer_load_dwordx4 v[208:211], v228, s[16:19], s30 offen offset:1024 sc1
s_add_u32 s29, s29, 2048
s_add_u32 s30, s30, 2048
buffer_load_dwordx4 v[212:215], v228, s[16:19], s29 offen offset:0 sc1
buffer_load_dwordx4 v[216:219], v228, s[16:19], s30 offen offset:0 sc1
buffer_load_dwordx4 v[220:223], v228, s[16:19], s29 offen offset:1024 sc1
buffer_load_dwordx4 v[224:227], v228, s[16:19], s30 offen offset:1024 sc1
s_add_u32 s29, s29, 2048
s_add_u32 s30, s30, 2048
s_waitcnt vmcnt(32)
s_waitcnt vmcnt(14)
v_mfma_f32_32x32x16_bf16 v[4:19], v[68:71], v[164:167], 0
v_mfma_f32_32x32x16_bf16 v[20:35], v[68:71], v[168:171], 0
v_mfma_f32_32x32x16_bf16 v[36:51], v[72:75], v[164:167], 0
v_mfma_f32_32x32x16_bf16 v[52:67], v[72:75], v[168:171], 0
buffer_load_dwordx4 v[164:167], v228, s[16:19], s29 offen offset:0 sc1
buffer_load_dwordx4 v[168:171], v228, s[16:19], s30 offen offset:0 sc1
ds_read_b64_tr_b16 v[68:69], v229 offset:4096
ds_read_b64_tr_b16 v[70:71], v229 offset:5120
ds_read_b64_tr_b16 v[72:73], v230 offset:4096
ds_read_b64_tr_b16 v[74:75], v230 offset:5120
s_waitcnt vmcnt(14)
v_mfma_f32_32x32x16_bf16 v[4:19], v[76:79], v[172:175], v[4:19]
v_mfma_f32_32x32x16_bf16 v[20:35], v[76:79], v[176:179], v[20:35]
v_mfma_f32_32x32x16_bf16 v[36:51], v[80:83], v[172:175], v[36:51]
v_mfma_f32_32x32x16_bf16 v[52:67], v[80:83], v[176:179], v[52:67]
buffer_load_dwordx4 v[172:175], v228, s[16:19], s29 offen offset:1024 sc1
buffer_load_dwordx4 v[176:179], v228, s[16:19], s30 offen offset:1024 sc1
s_add_u32 s29, s29, 2048
s_add_u32 s30, s30, 2048
ds_read_b64_tr_b16 v[76:77], v229 offset:6144
ds_read_b64_tr_b16 v[78:79], v229 offset:7168
ds_read_b64_tr_b16 v[80:81], v230 offset:6144
ds_read_b64_tr_b16 v[82:83], v230 offset:7168
s_waitcnt vmcnt(14)
v_mfma_f32_32x32x16_bf16 v[4:19], v[84:87], v[180:183], v[4:19]
v_mfma_f32_32x32x16_bf16 v[20:35], v[84:87], v[184:187], v[20:35]
v_mfma_f32_32x32x16_bf16 v[36:51], v[88:91], v[180:183], v[36:51]
v_mfma_f32_32x32x16_bf16 v[52:67], v[88:91], v[184:187], v[52:67]
buffer_load_dwordx4 v[180:183], v228, s[16:19], s29 offen offset:0 sc1
buffer_load_dwordx4 v[184:187], v228, s[16:19], s30 offen offset:0 sc1
ds_read_b64_tr_b16 v[84:85], v231 offset:0
ds_read_b64_tr_b16 v[86:87], v231 offset:1024
ds_read_b64_tr_b16 v[88:89], v232 offset:0
ds_read_b64_tr_b16 v[90:91], v232 offset:1024
s_waitcnt vmcnt(14)
v_mfma_f32_32x32x16_bf16 v[4:19], v[92:95], v[188:191], v[4:19]
v_mfma_f32_32x32x16_bf16 v[20:35], v[92:95], v[192:195], v[20:35]
v_mfma_f32_32x32x16_bf16 v[36:51], v[96:99], v[188:191], v[36:51]
v_mfma_f32_32x32x16_bf16 v[52:67], v[96:99], v[192:195], v[52:67]
buffer_load_dwordx4 v[188:191], v228, s[16:19], s29 offen offset:1024 sc1
buffer_load_dwordx4 v[192:195], v228, s[16:19], s30 offen offset:1024 sc1
s_add_u32 s29, s29, 2048
s_add_u32 s30, s30, 2048
ds_read_b64_tr_b16 v[92:93], v231 offset:2048
ds_read_b64_tr_b16 v[94:95], v231 offset:3072
ds_read_b64_tr_b16 v[96:97], v232 offset:2048
ds_read_b64_tr_b16 v[98:99], v232 offset:3072
s_waitcnt vmcnt(14)
v_mfma_f32_32x32x16_bf16 v[4:19], v[100:103], v[196:199], v[4:19]
v_mfma_f32_32x32x16_bf16 v[20:35], v[100:103], v[200:203], v[20:35]
v_mfma_f32_32x32x16_bf16 v[36:51], v[104:107], v[196:199], v[36:51]
v_mfma_f32_32x32x16_bf16 v[52:67], v[104:107], v[200:203], v[52:67]
buffer_load_dwordx4 v[196:199], v228, s[16:19], s29 offen offset:0 sc1
buffer_load_dwordx4 v[200:203], v228, s[16:19], s30 offen offset:0 sc1
ds_read_b64_tr_b16 v[100:101], v231 offset:4096
ds_read_b64_tr_b16 v[102:103], v231 offset:5120
ds_read_b64_tr_b16 v[104:105], v232 offset:4096
ds_read_b64_tr_b16 v[106:107], v232 offset:5120
s_waitcnt vmcnt(14)
v_mfma_f32_32x32x16_bf16 v[4:19], v[108:111], v[204:207], v[4:19]
v_mfma_f32_32x32x16_bf16 v[20:35], v[108:111], v[208:211], v[20:35]
v_mfma_f32_32x32x16_bf16 v[36:51], v[112:115], v[204:207], v[36:51]
v_mfma_f32_32x32x16_bf16 v[52:67], v[112:115], v[208:211], v[52:67]
buffer_load_dwordx4 v[204:207], v228, s[16:19], s29 offen offset:1024 sc1
buffer_load_dwordx4 v[208:211], v228, s[16:19], s30 offen offset:1024 sc1
s_add_u32 s29, s29, 2048
s_add_u32 s30, s30, 2048
ds_read_b64_tr_b16 v[108:109], v231 offset:6144
ds_read_b64_tr_b16 v[110:111], v231 offset:7168
ds_read_b64_tr_b16 v[112:113], v232 offset:6144
ds_read_b64_tr_b16 v[114:115], v232 offset:7168
s_waitcnt vmcnt(14)
v_mfma_f32_32x32x16_bf16 v[4:19], v[116:119], v[212:215], v[4:19]
v_mfma_f32_32x32x16_bf16 v[20:35], v[116:119], v[216:219], v[20:35]
v_mfma_f32_32x32x16_bf16 v[36:51], v[120:123], v[212:215], v[36:51]
v_mfma_f32_32x32x16_bf16 v[52:67], v[120:123], v[216:219], v[52:67]
buffer_load_dwordx4 v[212:215], v228, s[16:19], s29 offen offset:0 sc1
buffer_load_dwordx4 v[216:219], v228, s[16:19], s30 offen offset:0 sc1
ds_read_b64_tr_b16 v[116:117], v231 offset:8192
ds_read_b64_tr_b16 v[118:119], v231 offset:9216
ds_read_b64_tr_b16 v[120:121], v232 offset:8192
ds_read_b64_tr_b16 v[122:123], v232 offset:9216
s_waitcnt vmcnt(14)
v_mfma_f32_32x32x16_bf16 v[4:19], v[124:127], v[220:223], v[4:19]
v_mfma_f32_32x32x16_bf16 v[20:35], v[124:127], v[224:227], v[20:35]
v_mfma_f32_32x32x16_bf16 v[36:51], v[128:131], v[220:223], v[36:51]
v_mfma_f32_32x32x16_bf16 v[52:67], v[128:131], v[224:227], v[52:67]
buffer_load_dwordx4 v[220:223], v228, s[16:19], s29 offen offset:1024 sc1
buffer_load_dwordx4 v[224:227], v228, s[16:19], s30 offen offset:1024 sc1
s_add_u32 s29, s29, 2048
s_add_u32 s30, s30, 2048
ds_read_b64_tr_b16 v[124:125], v231 offset:10240
ds_read_b64_tr_b16 v[126:127], v231 offset:11264
ds_read_b64_tr_b16 v[128:129], v232 offset:10240
ds_read_b64_tr_b16 v[130:131], v232 offset:11264
s_lshl_b32 s36, s26, 12
s_add_u32 s36, s36, 65536
v_and_b32 v233, 31, v240
v_lshlrev_b32 v233, 7, v233
buffer_load_dword v243, v233, s[68:71], s36 offen sc1
s_waitcnt vmcnt(15)
v_mfma_f32_32x32x16_bf16 v[4:19], v[132:135], v[164:167], v[4:19]
v_mfma_f32_32x32x16_bf16 v[20:35], v[132:135], v[168:171], v[20:35]
v_mfma_f32_32x32x16_bf16 v[36:51], v[136:139], v[164:167], v[36:51]
v_mfma_f32_32x32x16_bf16 v[52:67], v[136:139], v[168:171], v[52:67]
buffer_load_dwordx4 v[164:167], v228, s[16:19], s29 offen offset:0 sc1
buffer_load_dwordx4 v[168:171], v228, s[16:19], s30 offen offset:0 sc1
ds_read_b64_tr_b16 v[132:133], v229 offset:0
ds_read_b64_tr_b16 v[134:135], v229 offset:1024
ds_read_b64_tr_b16 v[136:137], v230 offset:0
ds_read_b64_tr_b16 v[138:139], v230 offset:1024
s_waitcnt vmcnt(15)
v_mfma_f32_32x32x16_bf16 v[4:19], v[140:143], v[172:175], v[4:19]
v_mfma_f32_32x32x16_bf16 v[20:35], v[140:143], v[176:179], v[20:35]
v_mfma_f32_32x32x16_bf16 v[36:51], v[144:147], v[172:175], v[36:51]
v_mfma_f32_32x32x16_bf16 v[52:67], v[144:147], v[176:179], v[52:67]
buffer_load_dwordx4 v[172:175], v228, s[16:19], s29 offen offset:1024 sc1
buffer_load_dwordx4 v[176:179], v228, s[16:19], s30 offen offset:1024 sc1
s_add_u32 s29, s29, 2048
s_add_u32 s30, s30, 2048
ds_read_b64_tr_b16 v[140:141], v229 offset:2048
ds_read_b64_tr_b16 v[142:143], v229 offset:3072
ds_read_b64_tr_b16 v[144:145], v230 offset:2048
ds_read_b64_tr_b16 v[146:147], v230 offset:3072
s_waitcnt vmcnt(15)
v_mfma_f32_32x32x16_bf16 v[4:19], v[148:151], v[180:183], v[4:19]
v_mfma_f32_32x32x16_bf16 v[20:35], v[148:151], v[184:187], v[20:35]
v_mfma_f32_32x32x16_bf16 v[36:51], v[152:155], v[180:183], v[36:51]
v_mfma_f32_32x32x16_bf16 v[52:67], v[152:155], v[184:187], v[52:67]
buffer_load_dwordx4 v[180:183], v228, s[16:19], s29 offen offset:0 sc1
buffer_load_dwordx4 v[184:187], v228, s[16:19], s30 offen offset:0 sc1
s_waitcnt vmcnt(15)
v_mfma_f32_32x32x16_bf16 v[4:19], v[156:159], v[188:191], v[4:19]
v_mfma_f32_32x32x16_bf16 v[20:35], v[156:159], v[192:195], v[20:35]
v_mfma_f32_32x32x16_bf16 v[36:51], v[160:163], v[188:191], v[36:51]
v_mfma_f32_32x32x16_bf16 v[52:67], v[160:163], v[192:195], v[52:67]
buffer_load_dwordx4 v[188:191], v228, s[16:19], s29 offen offset:1024 sc1
buffer_load_dwordx4 v[192:195], v228, s[16:19], s30 offen offset:1024 sc1
s_add_u32 s29, s29, s34
s_add_u32 s30, s30, s34
s_waitcnt vmcnt(8)
v_cmp_ne_u32 vcc, s64, v243
s_nop 0
s_cbranch_vccnz fz_g2slow_13
v_mov_b32 v148, 0
v_mov_b32 v149, 0
v_mov_b32 v150, 0
v_mov_b32 v151, 0
v_mov_b32 v152, 0
v_mov_b32 v153, 0
v_mov_b32 v154, 0
v_mov_b32 v155, 0
v_mov_b32 v156, 0
v_mov_b32 v157, 0
v_mov_b32 v158, 0
v_mov_b32 v159, 0
v_mov_b32 v160, 0
v_mov_b32 v161, 0
v_mov_b32 v162, 0
v_mov_b32 v163, 0
s_lshl_b32 s27, s37, 2
s_add_u32 s27, s27, 4194304
buffer_load_dword v241, v241, s[16:19], s27 offen sc1
s_add_u32 s27, s35, 0
buffer_load_short_d16_hi v148, v242, s[16:19], s27 offen sc1
s_add_u32 s27, s35, 4096
buffer_load_short_d16_hi v149, v242, s[16:19], s27 offen sc1
s_add_u32 s27, s35, 8192
buffer_load_short_d16_hi v150, v242, s[16:19], s27 offen sc1
s_add_u32 s27, s35, 12288
buffer_load_short_d16_hi v151, v242, s[16:19], s27 offen sc1
s_add_u32 s27, s35, 32768
buffer_load_short_d16_hi v152, v242, s[16:19], s27 offen sc1
s_add_u32 s27, s35, 36864
buffer_load_short_d16_hi v153, v242, s[16:19], s27 offen sc1
s_add_u32 s27, s35, 40960
buffer_load_short_d16_hi v154, v242, s[16:19], s27 offen sc1
s_add_u32 s27, s35, 45056
buffer_load_short_d16_hi v155, v242, s[16:19], s27 offen sc1
s_add_u32 s27, s35, 65536
buffer_load_short_d16_hi v156, v242, s[16:19], s27 offen sc1
s_add_u32 s27, s35, 69632
buffer_load_short_d16_hi v157, v242, s[16:19], s27 offen sc1
s_add_u32 s27, s35, 73728
buffer_load_short_d16_hi v158, v242, s[16:19], s27 offen sc1
s_add_u32 s27, s35, 77824
buffer_load_short_d16_hi v159, v242, s[16:19], s27 offen sc1
s_add_u32 s27, s35, 98304
buffer_load_short_d16_hi v160, v242, s[16:19], s27 offen sc1
s_add_u32 s27, s35, 102400
buffer_load_short_d16_hi v161, v242, s[16:19], s27 offen sc1
s_add_u32 s27, s35, 106496
buffer_load_short_d16_hi v162, v242, s[16:19], s27 offen sc1
s_add_u32 s27, s35, 110592
buffer_load_short_d16_hi v163, v242, s[16:19], s27 offen sc1
s_waitcnt lgkmcnt(15)
v_mfma_f32_32x32x16_bf16 v[4:19], v[68:71], v[196:199], v[4:19]
v_mfma_f32_32x32x16_bf16 v[20:35], v[68:71], v[200:203], v[20:35]
v_mfma_f32_32x32x16_bf16 v[36:51], v[72:75], v[196:199], v[36:51]
v_mfma_f32_32x32x16_bf16 v[52:67], v[72:75], v[200:203], v[52:67]
buffer_load_dwordx4 v[196:199], v228, s[16:19], s29 offen offset:0 sc1
buffer_load_dwordx4 v[200:203], v228, s[16:19], s30 offen offset:0 sc1
v_mfma_f32_32x32x16_bf16 v[4:19], v[76:79], v[204:207], v[4:19]
v_mfma_f32_32x32x16_bf16 v[20:35], v[76:79], v[208:211], v[20:35]
v_mfma_f32_32x32x16_bf16 v[36:51], v[80:83], v[204:207], v[36:51]
v_mfma_f32_32x32x16_bf16 v[52:67], v[80:83], v[208:211], v[52:67]
buffer_load_dwordx4 v[204:207], v228, s[16:19], s29 offen offset:1024 sc1
buffer_load_dwordx4 v[208:211], v228, s[16:19], s30 offen offset:1024 sc1
s_add_u32 s29, s29, 2048
s_add_u32 s30, s30, 2048
v_mfma_f32_32x32x16_bf16 v[4:19], v[84:87], v[212:215], v[4:19]
v_mfma_f32_32x32x16_bf16 v[20:35], v[84:87], v[216:219], v[20:35]
v_mfma_f32_32x32x16_bf16 v[36:51], v[88:91], v[212:215], v[36:51]
v_mfma_f32_32x32x16_bf16 v[52:67], v[88:91], v[216:219], v[52:67]
v_mfma_f32_32x32x16_bf16 v[4:19], v[92:95], v[220:223], v[4:19]
v_mfma_f32_32x32x16_bf16 v[20:35], v[92:95], v[224:227], v[20:35]
v_mfma_f32_32x32x16_bf16 v[36:51], v[96:99], v[220:223], v[36:51]
v_mfma_f32_32x32x16_bf16 v[52:67], v[96:99], v[224:227], v[52:67]
s_waitcnt vmcnt(27)
v_mfma_f32_32x32x16_bf16 v[4:19], v[100:103], v[164:167], v[4:19]
v_mfma_f32_32x32x16_bf16 v[20:35], v[100:103], v[168:171], v[20:35]
v_mfma_f32_32x32x16_bf16 v[36:51], v[104:107], v[164:167], v[36:51]
v_mfma_f32_32x32x16_bf16 v[52:67], v[104:107], v[168:171], v[52:67]
s_waitcnt vmcnt(25)
v_mfma_f32_32x32x16_bf16 v[4:19], v[108:111], v[172:175], v[4:19]
v_mfma_f32_32x32x16_bf16 v[20:35], v[108:111], v[176:179], v[20:35]
v_mfma_f32_32x32x16_bf16 v[36:51], v[112:115], v[172:175], v[36:51]
v_mfma_f32_32x32x16_bf16 v[52:67], v[112:115], v[176:179], v[52:67]
s_waitcnt vmcnt(23)
s_waitcnt lgkmcnt(12)
v_mfma_f32_32x32x16_bf16 v[4:19], v[116:119], v[180:183], v[4:19]
v_mfma_f32_32x32x16_bf16 v[20:35], v[116:119], v[184:187], v[20:35]
v_mfma_f32_32x32x16_bf16 v[36:51], v[120:123], v[180:183], v[36:51]
v_mfma_f32_32x32x16_bf16 v[52:67], v[120:123], v[184:187], v[52:67]
s_waitcnt vmcnt(21)
s_waitcnt lgkmcnt(8)
v_mfma_f32_32x32x16_bf16 v[4:19], v[124:127], v[188:191], v[4:19]
v_mfma_f32_32x32x16_bf16 v[20:35], v[124:127], v[192:195], v[20:35]
v_mfma_f32_32x32x16_bf16 v[36:51], v[128:131], v[188:191], v[36:51]
v_mfma_f32_32x32x16_bf16 v[52:67], v[128:131], v[192:195], v[52:67]
s_waitcnt vmcnt(2)
s_waitcnt lgkmcnt(4)
s_cmp_eq_u32 s24, 3
s_cbranch_scc1 fz_g2fin_12
v_mfma_f32_32x32x16_bf16 v[4:19], v[132:135], v[196:199], v[4:19]
v_mfma_f32_32x32x16_bf16 v[20:35], v[132:135], v[200:203], v[20:35]
v_mfma_f32_32x32x16_bf16 v[36:51], v[136:139], v[196:199], v[36:51]
v_mfma_f32_32x32x16_bf16 v[52:67], v[136:139], v[200:203], v[52:67]
s_waitcnt vmcnt(0)
s_waitcnt lgkmcnt(0)
v_mfma_f32_32x32x16_bf16 v[4:19], v[140:143], v[204:207], v[4:19]
v_mfma_f32_32x32x16_bf16 v[20:35], v[140:143], v[208:211], v[20:35]
v_mfma_f32_32x32x16_bf16 v[36:51], v[144:147], v[204:207], v[36:51]
v_mfma_f32_32x32x16_bf16 v[52:67], v[144:147], v[208:211], v[52:67]
fz_g2fin_12:
s_branch fz_g2join_15
fz_g2slow_13:
s_waitcnt lgkmcnt(15)
v_mfma_f32_32x32x16_bf16 v[4:19], v[68:71], v[196:199], v[4:19]
v_mfma_f32_32x32x16_bf16 v[20:35], v[68:71], v[200:203], v[20:35]
v_mfma_f32_32x32x16_bf16 v[36:51], v[72:75], v[196:199], v[36:51]
v_mfma_f32_32x32x16_bf16 v[52:67], v[72:75], v[200:203], v[52:67]
buffer_load_dwordx4 v[196:199], v228, s[16:19], s29 offen offset:0 sc1
buffer_load_dwordx4 v[200:203], v228, s[16:19], s30 offen offset:0 sc1
v_mfma_f32_32x32x16_bf16 v[4:19], v[76:79], v[204:207], v[4:19]
v_mfma_f32_32x32x16_bf16 v[20:35], v[76:79], v[208:211], v[20:35]
v_mfma_f32_32x32x16_bf16 v[36:51], v[80:83], v[204:207], v[36:51]
v_mfma_f32_32x32x16_bf16 v[52:67], v[80:83], v[208:211], v[52:67]
buffer_load_dwordx4 v[204:207], v228, s[16:19], s29 offen offset:1024 sc1
buffer_load_dwordx4 v[208:211], v228, s[16:19], s30 offen offset:1024 sc1
s_add_u32 s29, s29, 2048
s_add_u32 s30, s30, 2048
v_mfma_f32_32x32x16_bf16 v[4:19], v[84:87], v[212:215], v[4:19]
v_mfma_f32_32x32x16_bf16 v[20:35], v[84:87], v[216:219], v[20:35]
v_mfma_f32_32x32x16_bf16 v[36:51], v[88:91], v[212:215], v[36:51]
v_mfma_f32_32x32x16_bf16 v[52:67], v[88:91], v[216:219], v[52:67]
v_mfma_f32_32x32x16_bf16 v[4:19], v[92:95], v[220:223], v[4:19]
v_mfma_f32_32x32x16_bf16 v[20:35], v[92:95], v[224:227], v[20:35]
v_mfma_f32_32x32x16_bf16 v[36:51], v[96:99], v[220:223], v[36:51]
v_mfma_f32_32x32x16_bf16 v[52:67], v[96:99], v[224:227], v[52:67]
s_waitcnt vmcnt(10)
v_mfma_f32_32x32x16_bf16 v[4:19], v[100:103], v[164:167], v[4:19]
v_mfma_f32_32x32x16_bf16 v[20:35], v[100:103], v[168:171], v[20:35]
v_mfma_f32_32x32x16_bf16 v[36:51], v[104:107], v[164:167], v[36:51]
v_mfma_f32_32x32x16_bf16 v[52:67], v[104:107], v[168:171], v[52:67]
s_waitcnt vmcnt(8)
v_mfma_f32_32x32x16_bf16 v[4:19], v[108:111], v[172:175], v[4:19]
v_mfma_f32_32x32x16_bf16 v[20:35], v[108:111], v[176:179], v[20:35]
v_mfma_f32_32x32x16_bf16 v[36:51], v[112:115], v[172:175], v[36:51]
v_mfma_f32_32x32x16_bf16 v[52:67], v[112:115], v[176:179], v[52:67]
s_waitcnt vmcnt(6)
s_waitcnt lgkmcnt(12)
v_mfma_f32_32x32x16_bf16 v[4:19], v[116:119], v[180:183], v[4:19]
v_mfma_f32_32x32x16_bf16 v[20:35], v[116:119], v[184:187], v[20:35]
v_mfma_f32_32x32x16_bf16 v[36:51], v[120:123], v[180:183], v[36:51]
v_mfma_f32_32x32x16_bf16 v[52:67], v[120:123], v[184:187], v[52:67]
s_waitcnt vmcnt(4)
s_waitcnt lgkmcnt(8)
v_mfma_f32_32x32x16_bf16 v[4:19], v[124:127], v[188:191], v[4:19]
v_mfma_f32_32x32x16_bf16 v[20:35], v[124:127], v[192:195], v[20:35]
v_mfma_f32_32x32x16_bf16 v[36:51], v[128:131], v[188:191], v[36:51]
v_mfma_f32_32x32x16_bf16 v[52:67], v[128:131], v[192:195], v[52:67]
s_waitcnt vmcnt(2)
s_waitcnt lgkmcnt(4)
s_cmp_eq_u32 s24, 3
s_cbranch_scc1 fz_g2finS_14
v_mfma_f32_32x32x16_bf16 v[4:19], v[132:135], v[196:199], v[4:19]
v_mfma_f32_32x32x16_bf16 v[20:35], v[132:135], v[200:203], v[20:35]
v_mfma_f32_32x32x16_bf16 v[36:51], v[136:139], v[196:199], v[36:51]
v_mfma_f32_32x32x16_bf16 v[52:67], v[136:139], v[200:203], v[52:67]
s_waitcnt vmcnt(0)
s_waitcnt lgkmcnt(0)
v_mfma_f32_32x32x16_bf16 v[4:19], v[140:143], v[204:207], v[4:19]
v_mfma_f32_32x32x16_bf16 v[20:35], v[140:143], v[208:211], v[20:35]
v_mfma_f32_32x32x16_bf16 v[36:51], v[144:147], v[204:207], v[36:51]
v_mfma_f32_32x32x16_bf16 v[52:67], v[144:147], v[208:211], v[52:67]
fz_g2finS_14:
s_mov_b32 s65, 0
fz_sl_17:
buffer_load_dword v243, v233, s[68:71], s36 offen sc1
s_add_u32 s65, s65, 1
s_waitcnt vmcnt(0)
v_cmp_ne_u32 vcc, s64, v243
s_nop 0
s_cbranch_vccz fz_sd_16
s_sleep 1
s_cmp_lt_u32 s65, 4096
s_cbranch_scc1 fz_sl_17
fz_sd_16:
v_mov_b32 v148, 0
v_mov_b32 v149, 0
v_mov_b32 v150, 0
v_mov_b32 v151, 0
v_mov_b32 v152, 0
v_mov_b32 v153, 0
v_mov_b32 v154, 0
v_mov_b32 v155, 0
v_mov_b32 v156, 0
v_mov_b32 v157, 0
v_mov_b32 v158, 0
v_mov_b32 v159, 0
v_mov_b32 v160, 0
v_mov_b32 v161, 0
v_mov_b32 v162, 0
v_mov_b32 v163, 0
s_lshl_b32 s27, s37, 2
s_add_u32 s27, s27, 4194304
buffer_load_dword v241, v241, s[16:19], s27 offen sc1
s_add_u32 s27, s35, 0
buffer_load_short_d16_hi v148, v242, s[16:19], s27 offen sc1
s_add_u32 s27, s35, 4096
buffer_load_short_d16_hi v149, v242, s[16:19], s27 offen sc1
s_add_u32 s27, s35, 8192
buffer_load_short_d16_hi v150, v242, s[16:19], s27 offen sc1
s_add_u32 s27, s35, 12288
buffer_load_short_d16_hi v151, v242, s[16:19], s27 offen sc1
s_add_u32 s27, s35, 32768
buffer_load_short_d16_hi v152, v242, s[16:19], s27 offen sc1
s_add_u32 s27, s35, 36864
buffer_load_short_d16_hi v153, v242, s[16:19], s27 offen sc1
s_add_u32 s27, s35, 40960
buffer_load_short_d16_hi v154, v242, s[16:19], s27 offen sc1
s_add_u32 s27, s35, 45056
buffer_load_short_d16_hi v155, v242, s[16:19], s27 offen sc1
s_add_u32 s27, s35, 65536
buffer_load_short_d16_hi v156, v242, s[16:19], s27 offen sc1
s_add_u32 s27, s35, 69632
buffer_load_short_d16_hi v157, v242, s[16:19], s27 offen sc1
s_add_u32 s27, s35, 73728
buffer_load_short_d16_hi v158, v242, s[16:19], s27 offen sc1
s_add_u32 s27, s35, 77824
buffer_load_short_d16_hi v159, v242, s[16:19], s27 offen sc1
s_add_u32 s27, s35, 98304
buffer_load_short_d16_hi v160, v242, s[16:19], s27 offen sc1
s_add_u32 s27, s35, 102400
buffer_load_short_d16_hi v161, v242, s[16:19], s27 offen sc1
s_add_u32 s27, s35, 106496
buffer_load_short_d16_hi v162, v242, s[16:19], s27 offen sc1
s_add_u32 s27, s35, 110592
buffer_load_short_d16_hi v163, v242, s[16:19], s27 offen sc1
fz_g2join_15:
v_lshlrev_b32 v233, 4, v240
v_add_u32 v231, s33, v233
v_add_u32 v229, s32, v233
s_waitcnt lgkmcnt(0)
s_nop 3
s_cmp_eq_u32 s24, 0
s_cbranch_scc1 fz_epo_18
ds_write_b128 v231, v[4:7] offset:0
ds_write_b128 v231, v[8:11] offset:1024
ds_write_b128 v231, v[12:15] offset:2048
ds_write_b128 v231, v[16:19] offset:3072
s_branch fz_epn_19
fz_epo_18:
v_mov_b32 v164, v4
v_mov_b32 v165, v5
v_mov_b32 v166, v6
v_mov_b32 v167, v7
v_mov_b32 v168, v8
v_mov_b32 v169, v9
v_mov_b32 v170, v10
v_mov_b32 v171, v11
v_mov_b32 v172, v12
v_mov_b32 v173, v13
v_mov_b32 v174, v14
v_mov_b32 v175, v15
v_mov_b32 v176, v16
v_mov_b32 v177, v17
v_mov_b32 v178, v18
v_mov_b32 v179, v19
fz_epn_19:
s_cmp_eq_u32 s24, 1
s_cbranch_scc1 fz_epo_20
ds_write_b128 v231, v[36:39] offset:4096
ds_write_b128 v231, v[40:43] offset:5120
ds_write_b128 v231, v[44:47] offset:6144
ds_write_b128 v231, v[48:51] offset:7168
s_branch fz_epn_21
fz_epo_20:
v_mov_b32 v164, v36
v_mov_b32 v165, v37
v_mov_b32 v166, v38
v_mov_b32 v167, v39
v_mov_b32 v168, v40
v_mov_b32 v169, v41
v_mov_b32 v170, v42
v_mov_b32 v171, v43
v_mov_b32 v172, v44
v_mov_b32 v173, v45
v_mov_b32 v174, v46
v_mov_b32 v175, v47
v_mov_b32 v176, v48
v_mov_b32 v177, v49
v_mov_b32 v178, v50
v_mov_b32 v179, v51
fz_epn_21:
s_cmp_eq_u32 s24, 2
s_cbranch_scc1 fz_epo_22
ds_write_b128 v229, v[20:23] offset:0
ds_write_b128 v229, v[24:27] offset:1024
ds_write_b128 v229, v[28:31] offset:2048
ds_write_b128 v229, v[32:35] offset:3072
s_branch fz_epn_23
fz_epo_22:
v_mov_b32 v164, v20
v_mov_b32 v165, v21
v_mov_b32 v166, v22
v_mov_b32 v167, v23
v_mov_b32 v168, v24
v_mov_b32 v169, v25
v_mov_b32 v170, v26
v_mov_b32 v171, v27
v_mov_b32 v172, v28
v_mov_b32 v173, v29
v_mov_b32 v174, v30
v_mov_b32 v175, v31
v_mov_b32 v176, v32
v_mov_b32 v177, v33
v_mov_b32 v178, v34
v_mov_b32 v179, v35
fz_epn_23:
s_cmp_eq_u32 s24, 3
s_cbranch_scc1 fz_epo_24
ds_write_b128 v229, v[52:55] offset:4096
ds_write_b128 v229, v[56:59] offset:5120
ds_write_b128 v229, v[60:63] offset:6144
ds_write_b128 v229, v[64:67] offset:7168
s_branch fz_epn_25
fz_epo_24:
v_mov_b32 v164, v52
v_mov_b32 v165, v53
v_mov_b32 v166, v54
v_mov_b32 v167, v55
v_mov_b32 v168, v56
v_mov_b32 v169, v57
v_mov_b32 v170, v58
v_mov_b32 v171, v59
v_mov_b32 v172, v60
v_mov_b32 v173, v61
v_mov_b32 v174, v62
v_mov_b32 v175, v63
v_mov_b32 v176, v64
v_mov_b32 v177, v65
v_mov_b32 v178, v66
v_mov_b32 v179, v67
fz_epn_25:
s_add_u32 s27, s24, 1
s_and_b32 s27, s27, 3
s_cmp_ge_u32 s24, 2
s_mov_b32 s28, 12288
s_cselect_b32 s28, 8192, s28
s_mul_i32 s27, s27, s28
s_cmp_ge_u32 s24, 2
s_cselect_b32 s28, 49152, 0
s_add_u32 s27, s27, s28
s_and_b32 s28, s24, 1
s_lshl_b32 s28, s28, 12
s_add_u32 s27, s27, s28
v_add_u32 v230, s27, v233
s_add_u32 s27, s24, 2
s_and_b32 s27, s27, 3
s_cmp_ge_u32 s24, 2
s_mov_b32 s28, 12288
s_cselect_b32 s28, 8192, s28
s_mul_i32 s27, s27, s28
s_cmp_ge_u32 s24, 2
s_cselect_b32 s28, 49152, 0
s_add_u32 s27, s27, s28
s_and_b32 s28, s24, 1
s_lshl_b32 s28, s28, 12
s_add_u32 s27, s27, s28
v_add_u32 v232, s27, v233
s_add_u32 s27, s24, 3
s_and_b32 s27, s27, 3
s_cmp_ge_u32 s24, 2
s_mov_b32 s28, 12288
s_cselect_b32 s28, 8192, s28
s_mul_i32 s27, s27, s28
s_cmp_ge_u32 s24, 2
s_cselect_b32 s28, 49152, 0
s_add_u32 s27, s27, s28
s_and_b32 s28, s24, 1
s_lshl_b32 s28, s28, 12
s_add_u32 s27, s27, s28
v_add_u32 v235, s27, v233
v_and_b32 v233, 31, v240
v_lshrrev_b32 v234, 5, v240
v_lshlrev_b32 v233, 10, v233
v_lshl_add_u32 v233, v234, 4, v233
s_lshl_b32 s27, s37, 10
s_lshl_b32 s28, s26, 7
s_add_u32 s27, s27, s28
s_and_b32 s28, s24, 1
s_lshl_b32 s28, s28, 6
s_add_u32 s27, s27, s28
s_waitcnt lgkmcnt(0)
s_barrier
ds_read_b128 v[4:7], v230 offset:0
ds_read_b128 v[20:23], v232 offset:0
ds_read_b128 v[36:39], v235 offset:0
ds_read_b128 v[8:11], v230 offset:1024
ds_read_b128 v[24:27], v232 offset:1024
ds_read_b128 v[40:43], v235 offset:1024
ds_read_b128 v[12:15], v230 offset:2048
ds_read_b128 v[28:31], v232 offset:2048
ds_read_b128 v[44:47], v235 offset:2048
ds_read_b128 v[16:19], v230 offset:3072
ds_read_b128 v[32:35], v232 offset:3072
ds_read_b128 v[48:51], v235 offset:3072
s_waitcnt vmcnt(0)
v_sub_f32 v234, 1.0, v241
v_cvt_pk_bf16_f32 v234, v234, v234
v_lshlrev_b32 v234, 16, v234
v_pk_mul_f32 v[148:149], v[240:241], v[148:149] op_sel:[1,0] op_sel_hi:[1,1]
v_pk_mul_f32 v[150:151], v[240:241], v[150:151] op_sel:[1,0] op_sel_hi:[1,1]
v_pk_mul_f32 v[152:153], v[240:241], v[152:153] op_sel:[1,0] op_sel_hi:[1,1]
v_pk_mul_f32 v[154:155], v[240:241], v[154:155] op_sel:[1,0] op_sel_hi:[1,1]
v_pk_mul_f32 v[156:157], v[240:241], v[156:157] op_sel:[1,0] op_sel_hi:[1,1]
v_pk_mul_f32 v[158:159], v[240:241], v[158:159] op_sel:[1,0] op_sel_hi:[1,1]
v_pk_mul_f32 v[160:161], v[240:241], v[160:161] op_sel:[1,0] op_sel_hi:[1,1]
v_pk_mul_f32 v[162:163], v[240:241], v[162:163] op_sel:[1,0] op_sel_hi:[1,1]
s_waitcnt lgkmcnt(9)
v_pk_add_f32 v[164:165], v[164:165], v[4:5]
v_pk_add_f32 v[20:21], v[20:21], v[36:37]
v_pk_add_f32 v[166:167], v[166:167], v[6:7]
v_pk_add_f32 v[22:23], v[22:23], v[38:39]
v_pk_add_f32 v[164:165], v[164:165], v[20:21]
v_pk_add_f32 v[166:167], v[166:167], v[22:23]
v_pk_fma_f32 v[164:165], v[234:235], v[164:165], v[148:149] op_sel:[0,0,0] op_sel_hi:[0,1,1]
v_pk_fma_f32 v[166:167], v[234:235], v[166:167], v[150:151] op_sel:[0,0,0] op_sel_hi:[0,1,1]
v_cvt_pk_bf16_f32 v68, v164, v165
v_cvt_pk_bf16_f32 v69, v166, v167
s_waitcnt lgkmcnt(6)
v_pk_add_f32 v[168:169], v[168:169], v[8:9]
v_pk_add_f32 v[24:25], v[24:25], v[40:41]
v_pk_add_f32 v[170:171], v[170:171], v[10:11]
v_pk_add_f32 v[26:27], v[26:27], v[42:43]
v_pk_add_f32 v[168:169], v[168:169], v[24:25]
v_pk_add_f32 v[170:171], v[170:171], v[26:27]
v_pk_fma_f32 v[168:169], v[234:235], v[168:169], v[152:153] op_sel:[0,0,0] op_sel_hi:[0,1,1]
v_pk_fma_f32 v[170:171], v[234:235], v[170:171], v[154:155] op_sel:[0,0,0] op_sel_hi:[0,1,1]
v_cvt_pk_bf16_f32 v70, v168, v169
v_cvt_pk_bf16_f32 v71, v170, v171
s_nop 1
v_permlane32_swap_b32 v68, v70
v_permlane32_swap_b32 v69, v71
s_nop 1
buffer_store_dwordx4 v[68:71], v233, s[20:23], s27 offen offset:0
s_waitcnt lgkmcnt(3)
v_pk_add_f32 v[172:173], v[172:173], v[12:13]
v_pk_add_f32 v[28:29], v[28:29], v[44:45]
v_pk_add_f32 v[174:175], v[174:175], v[14:15]
v_pk_add_f32 v[30:31], v[30:31], v[46:47]
v_pk_add_f32 v[172:173], v[172:173], v[28:29]
v_pk_add_f32 v[174:175], v[174:175], v[30:31]
v_pk_fma_f32 v[172:173], v[234:235], v[172:173], v[156:157] op_sel:[0,0,0] op_sel_hi:[0,1,1]
v_pk_fma_f32 v[174:175], v[234:235], v[174:175], v[158:159] op_sel:[0,0,0] op_sel_hi:[0,1,1]
v_cvt_pk_bf16_f32 v72, v172, v173
v_cvt_pk_bf16_f32 v73, v174, v175
s_waitcnt lgkmcnt(0)
v_pk_add_f32 v[176:177], v[176:177], v[16:17]
v_pk_add_f32 v[32:33], v[32:33], v[48:49]
v_pk_add_f32 v[178:179], v[178:179], v[18:19]
v_pk_add_f32 v[34:35], v[34:35], v[50:51]
v_pk_add_f32 v[176:177], v[176:177], v[32:33]
v_pk_add_f32 v[178:179], v[178:179], v[34:35]
v_pk_fma_f32 v[176:177], v[234:235], v[176:177], v[160:161] op_sel:[0,0,0] op_sel_hi:[0,1,1]
v_pk_fma_f32 v[178:179], v[234:235], v[178:179], v[162:163] op_sel:[0,0,0] op_sel_hi:[0,1,1]
v_cvt_pk_bf16_f32 v74, v176, v177
v_cvt_pk_bf16_f32 v75, v178, v179
s_nop 1
v_permlane32_swap_b32 v72, v74
v_permlane32_swap_b32 v73, v75
s_nop 1
buffer_store_dwordx4 v[72:75], v233, s[20:23], s27 offen offset:32
s_endpgm
fz_ssm:
s_setprio 1
s_load_dwordx2 s[4:5], s[0:1], 8
s_load_dwordx2 s[6:7], s[0:1], 16
s_load_dwordx2 s[8:9], s[0:1], 24
s_load_dwordx2 s[10:11], s[0:1], 32
s_load_dwordx2 s[12:13], s[0:1], 40
s_load_dwordx2 s[14:15], s[0:1], 48
s_load_dwordx2 s[16:17], s[0:1], 56
s_load_dwordx2 s[18:19], s[0:1], 64
s_load_dwordx2 s[20:21], s[0:1], 128
s_load_dwordx2 s[22:23], s[0:1], 0
v_lshrrev_b32 v4, 6, v0
v_and_b32 v1, 63, v0
v_readfirstlane_b32 s36, v4
v_lshrrev_b32 v2, 5, v1
v_and_b32 v3, 31, v1
s_lshr_b32 s37, s36, 1
s_and_b32 s38, s36, 1
s_lshl_b32 s39, s2, 1
s_add_u32 s39, s39, s37
s_lshl_b32 s40, s2, 2
s_and_b32 s50, s2, 31
s_lshr_b32 s51, s2, 5
s_lshl_b32 s56, s50, 16
s_lshl_b32 s57, s51, 7
s_add_u32 s56, s56, s57
s_add_u32 s57, s56, 32768
v_lshrrev_b32 v200, 3, v0
v_and_b32 v201, 7, v0
v_lshlrev_b32 v202, 10, v200
v_lshl_add_u32 v202, v201, 4, v202
s_waitcnt lgkmcnt(0)
s_mov_b32 s52, s22
s_mov_b32 s53, s23
s_mov_b32 s54, 2097152
s_mov_b32 s55, 0x00020000
buffer_load_dwordx4 v[204:207], v202, s[52:55], s56 offen
buffer_load_dwordx4 v[208:211], v202, s[52:55], s57 offen
s_add_u32 s68, s66, 5242880
s_addc_u32 s69, s67, 0
s_mov_b32 s70, 99328
s_mov_b32 s71, 0x00020000
s_mov_b32 s74, 256
s_mov_b32 s75, 0x00020000
s_or_b32 s65, s2, s36
s_cmp_lg_u32 s65, 0
s_cbranch_scc1 fz_nw_26
s_memrealtime s[66:67]
s_waitcnt lgkmcnt(0)
s_or_b32 s66, s66, 1
v_mov_b32 v203, s66
s_mov_b64 exec, 1
buffer_store_dword v203, off, s[72:75], 0 sc1
s_mov_b64 exec, -1
fz_nw_26:
s_load_dword s42, s[16:17], s40
s_load_dword s43, s[18:19], s40
s_lshl_b32 s44, s39, 8
s_lshl_b32 s40, s38, 7
s_add_u32 s44, s44, s40
v_lshlrev_b32 v4, 1, v1
s_mov_b32 s26, 131072
s_mov_b32 s27, 0x00020000
s_mov_b32 s24, s4
s_mov_b32 s25, s5
buffer_load_ushort v20, v4, s[24:27], s44 offen
s_mov_b32 s24, s6
s_mov_b32 s25, s7
buffer_load_ushort v21, v4, s[24:27], s44 offen
s_mov_b32 s24, s8
s_mov_b32 s25, s9
buffer_load_ushort v22, v4, s[24:27], s44 offen
s_mov_b32 s24, s10
s_mov_b32 s25, s11
buffer_load_ushort v23, v4, s[24:27], s44 offen
s_mov_b32 s24, s12
s_mov_b32 s25, s13
buffer_load_ushort v24, v4, s[24:27], s44 offen
s_mov_b32 s24, s14
s_mov_b32 s25, s15
buffer_load_ushort v25, v4, s[24:27], s44 offen
s_mov_b32 s28, s20
s_mov_b32 s29, s21
s_mov_b32 s30, 2097152
s_mov_b32 s31, 0x00020000
s_add_u32 s32, s20, 16777216
s_addc_u32 s33, s21, 0
s_mov_b32 s34, 2097152
s_mov_b32 s35, 0x00020000
s_lshl_b32 s44, s39, 12
s_lshl_b32 s40, s38, 11
s_add_u32 s44, s44, s40
v_mul_u32_u24 v212, 132, v200
v_lshl_add_u32 v212, v201, 4, v212
v_add_u32 v212, 69632, v212
v_add_u32 v213, 4224, v212
v_mul_u32_u24 v214, 1056, v201
v_lshl_add_u32 v214, v200, 1, v214
v_add_u32 v214, 69632, v214
s_lshl_b32 s56, s51, 18
s_lshl_b32 s57, s50, 7
s_add_u32 s56, s56, s57
s_add_u32 s57, s56, 131072
v_lshlrev_b32 v202, 12, v200
v_lshl_add_u32 v202, v201, 4, v202
s_waitcnt vmcnt(7)
ds_write2_b32 v212, v204, v205 offset0:0 offset1:1
ds_write2_b32 v212, v206, v207 offset0:2 offset1:3
s_waitcnt vmcnt(6)
ds_write2_b32 v213, v208, v209 offset0:0 offset1:1
ds_write2_b32 v213, v210, v211 offset0:2 offset1:3
s_waitcnt lgkmcnt(0)
s_barrier
ds_read_u16 v216, v214 offset:0
ds_read_u16 v217, v214 offset:132
ds_read_u16 v218, v214 offset:264
ds_read_u16 v219, v214 offset:396
ds_read_u16 v220, v214 offset:528
ds_read_u16 v221, v214 offset:660
ds_read_u16 v222, v214 offset:792
ds_read_u16 v223, v214 offset:924
ds_read_u16 v224, v214 offset:64
ds_read_u16 v225, v214 offset:196
ds_read_u16 v226, v214 offset:328
ds_read_u16 v227, v214 offset:460
ds_read_u16 v228, v214 offset:592
ds_read_u16 v229, v214 offset:724
ds_read_u16 v230, v214 offset:856
ds_read_u16 v231, v214 offset:988
s_waitcnt lgkmcnt(0)
v_lshl_or_b32 v204, v217, 16, v216
v_lshl_or_b32 v205, v219, 16, v218
v_lshl_or_b32 v206, v221, 16, v220
v_lshl_or_b32 v207, v223, 16, v222
v_lshl_or_b32 v208, v225, 16, v224
v_lshl_or_b32 v209, v227, 16, v226
v_lshl_or_b32 v210, v229, 16, v228
v_lshl_or_b32 v211, v231, 16, v230
buffer_store_dwordx4 v[204:207], v202, s[28:31], s56 offen sc1
buffer_store_dwordx4 v[208:211], v202, s[28:31], s57 offen sc1
buffer_load_dword v203, off, s[72:75], 0 sc1
s_lshl_b32 s40, s37, 4
s_lshr_b32 s42, s42, s40
s_lshl_b32 s42, s42, 16
s_lshr_b32 s43, s43, s40
s_lshl_b32 s43, s43, 16
v_mov_b32 v26, 0x3fb8aa3b
v_mul_f32 v26, s42, v26
v_exp_f32 v26, v26
s_nop 0
v_cvt_pk_bf16_f32 v26, v26, v26
v_lshlrev_b32 v26, 16, v26
s_waitcnt vmcnt(3)
v_lshlrev_b32 v20, 16, v20
v_lshlrev_b32 v21, 16, v21
v_lshlrev_b32 v22, 16, v22
v_lshlrev_b32 v23, 16, v23
v_lshlrev_b32 v24, 16, v24
v_lshlrev_b32 v25, 16, v25
v_mul_f32 v27, v26, v20
v_mul_f32 v28, v26, v21
v_mul_f32 v22, v26, v22
v_mul_f32 v23, v26, v23
v_mul_f32 v4, v24, v22
v_mul_f32 v5, v24, v23
v_fma_f32 v29, -v25, v23, v4
v_fma_f32 v30, v25, v22, v5
v_mul_f32 v4, 0x3fb8aa3b, v27
v_mul_f32 v5, 0x3e22f983, v28
v_exp_f32 v4, v4
v_fract_f32 v5, v5
v_cos_f32 v31, v5
v_sin_f32 v32, v5
v_mul_f32 v31, v4, v31
v_mul_f32 v32, v4, v32
v_mul_f32 v4, 0x4138aa3b, v27
v_mul_f32 v5, 0x3fa2f983, v28
v_exp_f32 v4, v4
v_fract_f32 v5, v5
v_cos_f32 v33, v5
v_sin_f32 v34, v5
v_mul_f32 v33, v4, v33
v_mul_f32 v34, v4, v34
v_mul_f32 v4, 0x43b8aa3b, v27
v_mul_f32 v5, 0x4222f983, v28
v_exp_f32 v4, v4
v_fract_f32 v5, v5
v_cos_f32 v35, v5
v_sin_f32 v36, v5
v_mul_f32 v35, v4, v35
v_mul_f32 v36, v4, v36
s_mul_i32 s40, s36, 17408
s_add_u32 s40, s40, 0
v_lshlrev_b32 v37, 2, v1
v_add_u32 v37, s40, v37
v_mov_b32 v42, 1.0
v_mov_b32 v43, 0
v_cvt_pk_bf16_f32 v38, v42, v43
ds_write_b32 v37, v38 offset:8704
v_cvt_pk_bf16_f32 v39, v29, -v30
ds_write_b32 v37, v39 offset:0
v_mul_f32 v48, v29, v31
v_mul_f32 v49, v29, v32
v_fma_f32 v60, -v30, v32, v48
v_fma_f32 v61, v30, v31, v49
v_cvt_pk_bf16_f32 v40, v33, v34
ds_write_b32 v37, v40 offset:8976
v_cvt_pk_bf16_f32 v41, v60, -v61
ds_write_b32 v37, v41 offset:272
v_mul_f32 v46, v33, v33
v_mul_f32 v48, v60, v31
v_mul_f32 v47, v33, v34
v_mul_f32 v49, v60, v32
v_fma_f32 v42, -v34, v34, v46
v_fma_f32 v52, -v61, v32, v48
v_fma_f32 v43, v34, v33, v47
v_fma_f32 v53, v61, v31, v49
v_cvt_pk_bf16_f32 v38, v42, v43
ds_write_b32 v37, v38 offset:9248
v_cvt_pk_bf16_f32 v39, v52, -v53
ds_write_b32 v37, v39 offset:544
v_mul_f32 v46, v42, v33
v_mul_f32 v48, v52, v31
v_mul_f32 v47, v42, v34
v_mul_f32 v49, v52, v32
v_fma_f32 v44, -v43, v34, v46
v_fma_f32 v60, -v53, v32, v48
v_fma_f32 v45, v43, v33, v47
v_fma_f32 v61, v53, v31, v49
v_cvt_pk_bf16_f32 v40, v44, v45
ds_write_b32 v37, v40 offset:9520
v_cvt_pk_bf16_f32 v41, v60, -v61
ds_write_b32 v37, v41 offset:816
v_mul_f32 v46, v44, v33
v_mul_f32 v48, v60, v31
v_mul_f32 v47, v44, v34
v_mul_f32 v49, v60, v32
v_fma_f32 v42, -v45, v34, v46
v_fma_f32 v54, -v61, v32, v48
v_fma_f32 v43, v45, v33, v47
v_fma_f32 v55, v61, v31, v49
v_cvt_pk_bf16_f32 v38, v42, v43
ds_write_b32 v37, v38 offset:9792
v_cvt_pk_bf16_f32 v39, v54, -v55
ds_write_b32 v37, v39 offset:1088
v_mul_f32 v46, v42, v33
v_mul_f32 v48, v54, v31
v_mul_f32 v47, v42, v34
v_mul_f32 v49, v54, v32
v_fma_f32 v44, -v43, v34, v46
v_fma_f32 v60, -v55, v32, v48
v_fma_f32 v45, v43, v33, v47
v_fma_f32 v61, v55, v31, v49
v_cvt_pk_bf16_f32 v40, v44, v45
ds_write_b32 v37, v40 offset:10064
v_cvt_pk_bf16_f32 v41, v60, -v61
ds_write_b32 v37, v41 offset:1360
v_mul_f32 v46, v44, v33
v_mul_f32 v48, v60, v31
v_mul_f32 v47, v44, v34
v_mul_f32 v49, v60, v32
v_fma_f32 v42, -v45, v34, v46
v_fma_f32 v56, -v61, v32, v48
v_fma_f32 v43, v45, v33, v47
v_fma_f32 v57, v61, v31, v49
v_cvt_pk_bf16_f32 v38, v42, v43
ds_write_b32 v37, v38 offset:10336
v_cvt_pk_bf16_f32 v39, v56, -v57
ds_write_b32 v37, v39 offset:1632
v_mul_f32 v46, v42, v33
v_mul_f32 v48, v56, v31
v_mul_f32 v47, v42, v34
v_mul_f32 v49, v56, v32
v_fma_f32 v44, -v43, v34, v46
v_fma_f32 v60, -v57, v32, v48
v_fma_f32 v45, v43, v33, v47
v_fma_f32 v61, v57, v31, v49
v_cvt_pk_bf16_f32 v40, v44, v45
ds_write_b32 v37, v40 offset:10608
v_cvt_pk_bf16_f32 v41, v60, -v61
ds_write_b32 v37, v41 offset:1904
v_mul_f32 v46, v44, v33
v_mul_f32 v48, v60, v31
v_mul_f32 v47, v44, v34
v_mul_f32 v49, v60, v32
v_fma_f32 v42, -v45, v34, v46
v_fma_f32 v58, -v61, v32, v48
v_fma_f32 v43, v45, v33, v47
v_fma_f32 v59, v61, v31, v49
v_cvt_pk_bf16_f32 v38, v42, v43
ds_write_b32 v37, v38 offset:10880
v_mul_f32 v46, v42, v33
v_mul_f32 v48, v29, v35
v_mul_f32 v47, v42, v34
v_mul_f32 v49, v29, v36
v_fma_f32 v44, -v43, v34, v46
v_fma_f32 v29, -v30, v36, v48
v_fma_f32 v45, v43, v33, v47
v_fma_f32 v30, v30, v35, v49
v_cvt_pk_bf16_f32 v39, v44, v45
ds_write_b32 v37, v39 offset:11152
v_cvt_pk_bf16_f32 v40, v29, -v30
ds_write_b32 v37, v40 offset:4352
v_mul_f32 v46, v44, v33
v_mul_f32 v48, v52, v35
v_mul_f32 v47, v44, v34
v_mul_f32 v49, v52, v36
v_fma_f32 v42, -v45, v34, v46
v_fma_f32 v52, -v53, v36, v48
v_fma_f32 v43, v45, v33, v47
v_fma_f32 v53, v53, v35, v49
v_cvt_pk_bf16_f32 v41, v42, v43
ds_write_b32 v37, v41 offset:11424
v_cvt_pk_bf16_f32 v38, v52, -v53
ds_write_b32 v37, v38 offset:4624
v_mul_f32 v46, v42, v33
v_mul_f32 v48, v54, v35
v_mul_f32 v47, v42, v34
v_mul_f32 v49, v54, v36
v_fma_f32 v44, -v43, v34, v46
v_fma_f32 v54, -v55, v36, v48
v_fma_f32 v45, v43, v33, v47
v_fma_f32 v55, v55, v35, v49
v_cvt_pk_bf16_f32 v39, v44, v45
ds_write_b32 v37, v39 offset:11696
v_cvt_pk_bf16_f32 v40, v54, -v55
ds_write_b32 v37, v40 offset:4896
v_cvt_pk_bf16_f32 v41, v54, -v55
ds_write_b32 v37, v41 offset:5440
v_mul_f32 v46, v44, v33
v_mul_f32 v48, v56, v35
v_mul_f32 v47, v44, v34
v_mul_f32 v49, v56, v36
v_fma_f32 v42, -v45, v34, v46
v_fma_f32 v56, -v57, v36, v48
v_fma_f32 v43, v45, v33, v47
v_fma_f32 v57, v57, v35, v49
v_cvt_pk_bf16_f32 v38, v42, v43
ds_write_b32 v37, v38 offset:11968
v_cvt_pk_bf16_f32 v39, v56, -v57
ds_write_b32 v37, v39 offset:5712
v_mul_f32 v46, v42, v33
v_mul_f32 v48, v58, v35
v_mul_f32 v47, v42, v34
v_mul_f32 v49, v58, v36
v_fma_f32 v44, -v43, v34, v46
v_fma_f32 v58, -v59, v36, v48
v_fma_f32 v45, v43, v33, v47
v_fma_f32 v59, v59, v35, v49
v_cvt_pk_bf16_f32 v40, v44, v45
ds_write_b32 v37, v40 offset:12240
v_cvt_pk_bf16_f32 v41, v58, -v59
ds_write_b32 v37, v41 offset:5984
s_waitcnt vmcnt(0)
v_readfirstlane_b32 s64, v203
s_nop 0
s_cmp_lg_u32 s64, 0
s_cbranch_scc1 fz_ng_27
s_mov_b32 s65, 0
fz_nl_28:
s_sleep 1
buffer_load_dword v203, off, s[72:75], 0 sc1
s_add_u32 s65, s65, 1
s_waitcnt vmcnt(0)
v_readfirstlane_b32 s64, v203
s_nop 0
s_cmp_lg_u32 s64, 0
s_cbranch_scc1 fz_ng_27
s_cmp_lt_u32 s65, 4096
s_cbranch_scc1 fz_nl_28
fz_ng_27:
s_barrier
s_lshl_b32 s50, s2, 7
s_add_u32 s50, s50, 0
s_cmp_lg_u32 s36, 0
s_cbranch_scc1 fz_fl_29
v_mov_b32 v204, s64
s_mov_b64 exec, 1
buffer_store_dword v204, off, s[68:71], s50 sc1
s_mov_b64 exec, -1
fz_fl_29:
v_mul_f32 v46, v44, v33
v_mul_f32 v48, v29, v35
v_mul_f32 v47, v44, v34
v_mul_f32 v49, v29, v36
v_fma_f32 v42, -v45, v34, v46
v_fma_f32 v29, -v30, v36, v48
v_fma_f32 v43, v45, v33, v47
v_fma_f32 v30, v30, v35, v49
v_cvt_pk_bf16_f32 v38, v42, v43
ds_write_b32 v37, v38 offset:12512
v_cvt_pk_bf16_f32 v39, v29, -v30
ds_write_b32 v37, v39 offset:6528
v_mul_f32 v46, v42, v33
v_mul_f32 v48, v54, v35
v_mul_f32 v47, v42, v34
v_mul_f32 v49, v54, v36
v_fma_f32 v44, -v43, v34, v46
v_fma_f32 v54, -v55, v36, v48
v_fma_f32 v45, v43, v33, v47
v_fma_f32 v55, v55, v35, v49
v_cvt_pk_bf16_f32 v40, v44, v45
ds_write_b32 v37, v40 offset:12784
v_cvt_pk_bf16_f32 v41, v54, -v55
ds_write_b32 v37, v41 offset:6800
v_mul_f32 v46, v44, v33
v_mul_f32 v48, v58, v35
v_mul_f32 v47, v44, v34
v_mul_f32 v49, v58, v36
v_fma_f32 v42, -v45, v34, v46
v_fma_f32 v58, -v59, v36, v48
v_fma_f32 v43, v45, v33, v47
v_fma_f32 v59, v59, v35, v49
v_cvt_pk_bf16_f32 v38, v42, v43
ds_write_b32 v37, v38 offset:13056
v_cvt_pk_bf16_f32 v39, v58, -v59
ds_write_b32 v37, v39 offset:7072
v_mul_f32 v46, v42, v33
v_mul_f32 v48, v29, v35
v_mul_f32 v47, v42, v34
v_mul_f32 v49, v29, v36
v_fma_f32 v44, -v43, v34, v46
v_fma_f32 v29, -v30, v36, v48
v_fma_f32 v45, v43, v33, v47
v_fma_f32 v30, v30, v35, v49
v_cvt_pk_bf16_f32 v40, v44, v45
ds_write_b32 v37, v40 offset:13328
v_cvt_pk_bf16_f32 v41, v29, -v30
ds_write_b32 v37, v41 offset:7616
v_mul_f32 v46, v44, v33
v_mul_f32 v48, v54, v35
v_mul_f32 v47, v44, v34
v_mul_f32 v49, v54, v36
v_fma_f32 v42, -v45, v34, v46
v_fma_f32 v54, -v55, v36, v48
v_fma_f32 v43, v45, v33, v47
v_fma_f32 v55, v55, v35, v49
v_cvt_pk_bf16_f32 v38, v42, v43
ds_write_b32 v37, v38 offset:13600
v_cvt_pk_bf16_f32 v39, v54, -v55
ds_write_b32 v37, v39 offset:7888
v_mul_f32 v46, v42, v33
v_mul_f32 v48, v58, v35
v_mul_f32 v47, v42, v34
v_mul_f32 v49, v58, v36
v_fma_f32 v44, -v43, v34, v46
v_fma_f32 v58, -v59, v36, v48
v_fma_f32 v45, v43, v33, v47
v_fma_f32 v59, v59, v35, v49
v_cvt_pk_bf16_f32 v40, v44, v45
ds_write_b32 v37, v40 offset:13872
v_cvt_pk_bf16_f32 v41, v58, -v59
ds_write_b32 v37, v41 offset:8160
v_mul_f32 v46, v44, v33
v_mul_f32 v48, v29, v35
v_mul_f32 v47, v44, v34
v_mul_f32 v49, v29, v36
v_fma_f32 v42, -v45, v34, v46
v_fma_f32 v29, -v30, v36, v48
v_fma_f32 v43, v45, v33, v47
v_fma_f32 v30, v30, v35, v49
v_cvt_pk_bf16_f32 v38, v42, v43
ds_write_b32 v37, v38 offset:14144
v_cvt_pk_bf16_f32 v39, v29, -v30
ds_write_b32 v37, v39 offset:2176
v_mul_f32 v46, v42, v33
v_mul_f32 v48, v58, v35
v_mul_f32 v47, v42, v34
v_mul_f32 v49, v58, v36
v_fma_f32 v44, -v43, v34, v46
v_fma_f32 v58, -v59, v36, v48
v_fma_f32 v45, v43, v33, v47
v_fma_f32 v59, v59, v35, v49
v_cvt_pk_bf16_f32 v40, v44, v45
ds_write_b32 v37, v40 offset:14416
v_cvt_pk_bf16_f32 v41, v58, -v59
ds_write_b32 v37, v41 offset:2448
v_mul_f32 v46, v44, v33
v_mul_f32 v48, v29, v35
v_mul_f32 v47, v44, v34
v_mul_f32 v49, v29, v36
v_fma_f32 v42, -v45, v34, v46
v_fma_f32 v29, -v30, v36, v48
v_fma_f32 v43, v45, v33, v47
v_fma_f32 v30, v30, v35, v49
v_cvt_pk_bf16_f32 v38, v42, v43
ds_write_b32 v37, v38 offset:14688
v_cvt_pk_bf16_f32 v39, v29, -v30
ds_write_b32 v37, v39 offset:2720
v_mul_f32 v46, v42, v33
v_mul_f32 v48, v58, v35
v_mul_f32 v47, v42, v34
v_mul_f32 v49, v58, v36
v_fma_f32 v44, -v43, v34, v46
v_fma_f32 v58, -v59, v36, v48
v_fma_f32 v45, v43, v33, v47
v_fma_f32 v59, v59, v35, v49
v_cvt_pk_bf16_f32 v40, v44, v45
ds_write_b32 v37, v40 offset:14960
v_cvt_pk_bf16_f32 v41, v58, -v59
ds_write_b32 v37, v41 offset:2992
v_mul_f32 v46, v44, v33
v_mul_f32 v48, v29, v35
v_mul_f32 v47, v44, v34
v_mul_f32 v49, v29, v36
v_fma_f32 v42, -v45, v34, v46
v_fma_f32 v29, -v30, v36, v48
v_fma_f32 v43, v45, v33, v47
v_fma_f32 v30, v30, v35, v49
v_cvt_pk_bf16_f32 v38, v42, v43
ds_write_b32 v37, v38 offset:15232
v_cvt_pk_bf16_f32 v39, v29, -v30
ds_write_b32 v37, v39 offset:3264
v_mul_f32 v46, v42, v33
v_mul_f32 v48, v58, v35
v_mul_f32 v47, v42, v34
v_mul_f32 v49, v58, v36
v_fma_f32 v44, -v43, v34, v46
v_fma_f32 v58, -v59, v36, v48
v_fma_f32 v45, v43, v33, v47
v_fma_f32 v59, v59, v35, v49
v_cvt_pk_bf16_f32 v40, v44, v45
ds_write_b32 v37, v40 offset:15504
v_cvt_pk_bf16_f32 v41, v58, -v59
ds_write_b32 v37, v41 offset:3536
v_mul_f32 v46, v44, v33
v_mul_f32 v48, v29, v35
v_mul_f32 v47, v44, v34
v_mul_f32 v49, v29, v36
v_fma_f32 v42, -v45, v34, v46
v_fma_f32 v29, -v30, v36, v48
v_fma_f32 v43, v45, v33, v47
v_fma_f32 v30, v30, v35, v49
v_cvt_pk_bf16_f32 v38, v42, v43
ds_write_b32 v37, v38 offset:15776
v_cvt_pk_bf16_f32 v39, v29, -v30
ds_write_b32 v37, v39 offset:3808
v_mul_f32 v46, v42, v33
v_mul_f32 v48, v58, v35
v_mul_f32 v47, v42, v34
v_mul_f32 v49, v58, v36
v_fma_f32 v44, -v43, v34, v46
v_fma_f32 v58, -v59, v36, v48
v_fma_f32 v45, v43, v33, v47
v_fma_f32 v59, v59, v35, v49
v_cvt_pk_bf16_f32 v40, v44, v45
ds_write_b32 v37, v40 offset:16048
v_cvt_pk_bf16_f32 v41, v58, -v59
ds_write_b32 v37, v41 offset:4080
v_mul_f32 v46, v44, v33
v_mul_f32 v47, v44, v34
v_fma_f32 v42, -v45, v34, v46
v_fma_f32 v43, v45, v33, v47
v_cvt_pk_bf16_f32 v38, v42, v43
ds_write_b32 v37, v38 offset:16320
v_mul_f32 v46, v42, v33
v_mul_f32 v47, v42, v34
v_fma_f32 v44, -v43, v34, v46
v_fma_f32 v45, v43, v33, v47
v_cvt_pk_bf16_f32 v39, v44, v45
ds_write_b32 v37, v39 offset:16592
v_mul_f32 v46, v44, v33
v_mul_f32 v47, v44, v34
v_fma_f32 v42, -v45, v34, v46
v_fma_f32 v43, v45, v33, v47
v_cvt_pk_bf16_f32 v40, v42, v43
ds_write_b32 v37, v40 offset:16864
v_mul_f32 v46, v42, v33
v_mul_f32 v47, v42, v34
v_fma_f32 v44, -v43, v34, v46
v_fma_f32 v45, v43, v33, v47
v_cvt_pk_bf16_f32 v41, v44, v45
ds_write_b32 v37, v41 offset:17136
v_lshlrev_b32 v204, 7, v3
s_lshr_b32 s50, s2, 5
s_lshl_b32 s50, s50, 12
s_add_u32 s50, s50, 0
buffer_load_dword v205, v204, s[68:71], s50 offen sc1
v_mul_u32_u24 v60, 272, v3
v_lshl_add_u32 v60, v2, 4, v60
s_mul_i32 s40, s36, 17408
s_add_u32 s40, s40, 0
v_add_u32 v60, s40, v60
v_mov_b32 v28, 0
v_mov_b32 v29, 0
v_mov_b32 v30, 0
v_mov_b32 v31, 0
v_mov_b32 v32, 0
v_mov_b32 v33, 0
v_mov_b32 v34, 0
v_mov_b32 v35, 0
v_mov_b32 v36, 0
v_mov_b32 v37, 0
v_mov_b32 v38, 0
v_mov_b32 v39, 0
v_mov_b32 v40, 0
v_mov_b32 v41, 0
v_mov_b32 v42, 0
v_mov_b32 v43, 0
s_waitcnt lgkmcnt(0)
ds_read_b128 v[44:47], v60 offset:0
ds_read_b128 v[52:55], v60 offset:8704
ds_read_b128 v[48:51], v60 offset:32
ds_read_b128 v[56:59], v60 offset:8736
s_waitcnt lgkmcnt(2)
v_mfma_f32_32x32x16_bf16 v[28:43], v[44:47], v[52:55], v[28:43]
ds_read_b128 v[44:47], v60 offset:64
ds_read_b128 v[52:55], v60 offset:8768
s_waitcnt lgkmcnt(2)
v_mfma_f32_32x32x16_bf16 v[28:43], v[48:51], v[56:59], v[28:43]
ds_read_b128 v[48:51], v60 offset:96
ds_read_b128 v[56:59], v60 offset:8800
s_waitcnt lgkmcnt(2)
v_mfma_f32_32x32x16_bf16 v[28:43], v[44:47], v[52:55], v[28:43]
ds_read_b128 v[44:47], v60 offset:128
ds_read_b128 v[52:55], v60 offset:8832
s_waitcnt lgkmcnt(2)
v_mfma_f32_32x32x16_bf16 v[28:43], v[48:51], v[56:59], v[28:43]
ds_read_b128 v[48:51], v60 offset:160
ds_read_b128 v[56:59], v60 offset:8864
s_waitcnt lgkmcnt(2)
v_mfma_f32_32x32x16_bf16 v[28:43], v[44:47], v[52:55], v[28:43]
ds_read_b128 v[44:47], v60 offset:192
ds_read_b128 v[52:55], v60 offset:8896
s_waitcnt lgkmcnt(2)
v_mfma_f32_32x32x16_bf16 v[28:43], v[48:51], v[56:59], v[28:43]
ds_read_b128 v[48:51], v60 offset:224
ds_read_b128 v[56:59], v60 offset:8928
s_waitcnt lgkmcnt(2)
v_mfma_f32_32x32x16_bf16 v[28:43], v[44:47], v[52:55], v[28:43]
s_waitcnt lgkmcnt(0)
v_mfma_f32_32x32x16_bf16 v[28:43], v[48:51], v[56:59], v[28:43]
s_waitcnt vmcnt(0)
v_cmp_ne_u32 vcc, s64, v205
s_nop 0
s_cbranch_vccz fz_pc_30
s_mov_b32 s65, 0
fz_sl_32:
buffer_load_dword v205, v204, s[68:71], s50 offen sc1
s_add_u32 s65, s65, 1
s_waitcnt vmcnt(0)
v_cmp_ne_u32 vcc, s64, v205
s_nop 0
s_cbranch_vccz fz_sd_31
s_sleep 1
s_cmp_lt_u32 s65, 4096
s_cbranch_scc1 fz_sl_32
fz_sd_31:
fz_pc_30:
v_lshlrev_b32 v5, 5, v1
buffer_load_dwordx4 v[12:15], v5, s[28:31], s44 offen sc1
buffer_load_dwordx4 v[16:19], v5, s[28:31], s44 offen offset:16 sc1
s_lshl_b32 s40, s36, 11
s_add_u32 s40, s40, 69632
v_lshlrev_b32 v61, 4, v1
v_add_u32 v61, s40, v61
v_xor_b32 v62, 2048, v61
s_mul_i32 s45, s37, 25344
s_add_u32 s45, s45, 0
v_lshlrev_b32 v76, 4, v3
s_add_u32 s40, s45, 4080
v_sub_u32 v76, s40, v76
s_cmp_eq_u32 s38, 1
s_cbranch_scc1 fz_kf1_33
s_nop 7
s_nop 3
ds_write_b128 v61, v[36:39]
ds_write_b128 v61, v[40:43] offset:1024
s_waitcnt lgkmcnt(0)
s_barrier
ds_read_b128 v[64:67], v62
ds_read_b128 v[68:71], v62 offset:1024
s_waitcnt lgkmcnt(0)
v_add_f32 v28, v28, v64
v_add_f32 v29, v29, v65
v_add_f32 v30, v30, v66
v_add_f32 v31, v31, v67
v_add_f32 v32, v32, v68
v_add_f32 v33, v33, v69
v_add_f32 v34, v34, v70
v_add_f32 v35, v35, v71
v_xor_b32 v77, 1, v2
v_lshl_add_u32 v77, v77, 3, v76
v_cvt_pk_bf16_f32 v72, v31, v30
v_cvt_pk_bf16_f32 v73, v29, v28
ds_write_b64 v77, v[72:73]
v_and_b32 v77, 1, v3
v_cmp_eq_u32 vcc, 1, v77
v_lshlrev_b32 v77, 10, v2
v_sub_u32 v77, v76, v77
v_subrev_u32 v77, 2048, v77
v_cndmask_b32 v64, v32, v33, vcc
v_cvt_pk_bf16_f32 v72, v33, v33
v_cvt_pk_bf16_f32 v73, v33, v64
v_cvt_pk_bf16_f32 v74, v32, v32
v_cvt_pk_bf16_f32 v75, v32, v32
ds_write_b128 v77, v[72:75]
s_nop 1
v_lshlrev_b32 v77, 10, v2
v_sub_u32 v77, v76, v77
v_subrev_u32 v77, 2560, v77
v_cndmask_b32 v64, v34, v35, vcc
v_cvt_pk_bf16_f32 v72, v35, v35
v_cvt_pk_bf16_f32 v73, v35, v64
v_cvt_pk_bf16_f32 v74, v34, v34
v_cvt_pk_bf16_f32 v75, v34, v34
ds_write_b128 v77, v[72:75]
s_nop 1
s_branch fz_kfj_34
fz_kf1_33:
s_nop 7
s_nop 3
ds_write_b128 v61, v[28:31]
ds_write_b128 v61, v[32:35] offset:1024
s_waitcnt lgkmcnt(0)
s_barrier
ds_read_b128 v[64:67], v62
ds_read_b128 v[68:71], v62 offset:1024
s_waitcnt lgkmcnt(0)
v_add_f32 v36, v36, v64
v_add_f32 v37, v37, v65
v_add_f32 v38, v38, v66
v_add_f32 v39, v39, v67
v_add_f32 v40, v40, v68
v_add_f32 v41, v41, v69
v_add_f32 v42, v42, v70
v_add_f32 v43, v43, v71
v_xor_b32 v77, 1, v2
v_lshl_add_u32 v77, v77, 3, v76
v_subrev_u32 v77, 512, v77
v_cvt_pk_bf16_f32 v72, v38, v37
v_cvt_pk_bf16_f32 v73, v36, v36
ds_write_b64 v77, v[72:73]
v_lshlrev_b32 v77, 9, v2
v_sub_u32 v77, v76, v77
v_subrev_u32 v77, 1024, v77
v_cvt_pk_bf16_f32 v64, v42, v42
v_cvt_pk_bf16_f32 v65, v41, v41
v_cvt_pk_bf16_f32 v66, v41, v40
v_cvt_pk_bf16_f32 v67, v40, v40
ds_write_b128 v77, v[64:67]
fz_kfj_34:
s_lshl_b32 s40, s38, 6
v_add_u32 v78, s40, v1
v_mov_b32 v80, 0
v_mov_b32 v81, 0
v_mov_b32 v82, 0
v_mov_b32 v83, 0
v_lshrrev_b32 v4, 1, v78
v_mul_u32_u24 v4, 80, v4
v_and_b32 v5, 1, v78
v_lshl_add_u32 v4, v5, 5, v4
s_add_u32 s40, s45, 20144
v_add_u32 v4, s40, v4
s_waitcnt vmcnt(0)
ds_write_b128 v4, v[12:15]
ds_write_b128 v4, v[16:19] offset:16
v_lshlrev_b32 v6, 4, v78
s_add_u32 s40, s45, 17664
v_add_u32 v6, s40, v6
ds_write_b128 v6, v[80:83]
v_cmp_gt_u32 vcc, 27, v78
s_nop 0
s_and_saveexec_b64 s[46:47], vcc
ds_write_b128 v6, v[80:83] offset:2048
s_mov_b64 exec, s[46:47]
v_lshrrev_b32 v7, 3, v78
v_mul_u32_u24 v7, 4416, v7
v_and_b32 v8, 7, v78
v_lshl_add_u32 v7, v8, 4, v7
s_add_u32 s40, s45, 4096
v_add_u32 v7, s40, v7
v_cmp_gt_u32 vcc, 32, v78
s_nop 0
s_and_saveexec_b64 s[46:47], vcc
ds_write_b128 v7, v[80:83]
s_mov_b64 exec, s[46:47]
s_waitcnt lgkmcnt(0)
s_barrier
v_lshlrev_b32 v52, 4, v78
v_add_u32 v52, s45, v52
ds_read_b128 v[28:31], v52 offset:0
ds_read_b64 v[36:37], v52 offset:16
ds_read_b128 v[32:35], v52 offset:2048
ds_read_b64 v[38:39], v52 offset:2064
s_waitcnt lgkmcnt(2)
v_alignbit_b32 v40, v29, v28, 16
v_alignbit_b32 v41, v30, v29, 16
v_alignbit_b32 v42, v31, v30, 16
v_alignbit_b32 v43, v36, v31, 16
v_mov_b32 v44, v29
v_mov_b32 v45, v30
v_mov_b32 v46, v31
v_mov_b32 v47, v36
v_alignbit_b32 v48, v30, v29, 16
v_alignbit_b32 v49, v31, v30, 16
v_alignbit_b32 v50, v36, v31, 16
v_alignbit_b32 v51, v37, v36, 16
ds_write_b128 v52, v[40:43] offset:4416
ds_write_b128 v52, v[44:47] offset:8832
ds_write_b128 v52, v[48:51] offset:13248
s_nop 3
s_waitcnt lgkmcnt(3)
v_alignbit_b32 v40, v33, v32, 16
v_alignbit_b32 v41, v34, v33, 16
v_alignbit_b32 v42, v35, v34, 16
v_alignbit_b32 v43, v38, v35, 16
v_mov_b32 v44, v33
v_mov_b32 v45, v34
v_mov_b32 v46, v35
v_mov_b32 v47, v38
v_alignbit_b32 v48, v34, v33, 16
v_alignbit_b32 v49, v35, v34, 16
v_alignbit_b32 v50, v38, v35, 16
v_alignbit_b32 v51, v39, v38, 16
ds_write_b128 v52, v[40:43] offset:6464
ds_write_b128 v52, v[44:47] offset:10880
ds_write_b128 v52, v[48:51] offset:15296
s_waitcnt lgkmcnt(0)
s_barrier
v_and_b32 v4, 3, v3
v_sub_u32 v4, 3, v4
v_mul_u32_u24 v124, 4416, v4
v_lshrrev_b32 v5, 2, v3
v_lshlrev_b32 v5, 3, v5
v_sub_u32 v124, v124, v5
v_lshl_add_u32 v124, v2, 4, v124
s_lshl_b32 s40, s38, 10
s_sub_u32 s40, s45, s40
s_add_u32 s40, s40, 1080
v_add_u32 v124, s40, v124
v_mul_u32_u24 v125, 80, v3
v_lshl_add_u32 v125, v2, 4, v125
s_mul_i32 s40, s38, 1280
s_sub_u32 s40, s45, s40
s_add_u32 s40, s40, 18944
v_add_u32 v125, s40, v125
v_mov_b32 v28, 0
v_mov_b32 v29, 0
v_mov_b32 v30, 0
v_mov_b32 v31, 0
v_mov_b32 v32, 0
v_mov_b32 v33, 0
v_mov_b32 v34, 0
v_mov_b32 v35, 0
v_mov_b32 v36, 0
v_mov_b32 v37, 0
v_mov_b32 v38, 0
v_mov_b32 v39, 0
v_mov_b32 v40, 0
v_mov_b32 v41, 0
v_mov_b32 v42, 0
v_mov_b32 v43, 0
v_mov_b32 v44, 0
v_mov_b32 v45, 0
v_mov_b32 v46, 0
v_mov_b32 v47, 0
v_mov_b32 v48, 0
v_mov_b32 v49, 0
v_mov_b32 v50, 0
v_mov_b32 v51, 0
v_mov_b32 v52, 0
v_mov_b32 v53, 0
v_mov_b32 v54, 0
v_mov_b32 v55, 0
v_mov_b32 v56, 0
v_mov_b32 v57, 0
v_mov_b32 v58, 0
v_mov_b32 v59, 0
ds_read_b64 v[60:61], v124 offset:3008
ds_read_b64 v[62:63], v124 offset:3016
ds_read_b64 v[64:65], v124 offset:3040
ds_read_b64 v[66:67], v124 offset:3048
ds_read_b64 v[68:69], v124 offset:960
ds_read_b64 v[70:71], v124 offset:968
ds_read_b64 v[72:73], v124 offset:992
ds_read_b64 v[74:75], v124 offset:1000
ds_read_b128 v[92:95], v125 offset:1200
ds_read_b128 v[96:99], v125 offset:1232
ds_read_b128 v[100:103], v125 offset:3760
ds_read_b128 v[104:107], v125 offset:3792
ds_read_b64 v[76:77], v124 offset:2944
ds_read_b64 v[78:79], v124 offset:2952
ds_read_b64 v[80:81], v124 offset:2976
ds_read_b64 v[82:83], v124 offset:2984
ds_read_b64 v[84:85], v124 offset:896
ds_read_b64 v[86:87], v124 offset:904
ds_read_b64 v[88:89], v124 offset:928
ds_read_b64 v[90:91], v124 offset:936
ds_read_b128 v[108:111], v125 offset:1120
ds_read_b128 v[112:115], v125 offset:1152
ds_read_b128 v[116:119], v125 offset:3680
ds_read_b128 v[120:123], v125 offset:3712
s_waitcnt lgkmcnt(12)
v_mfma_f32_32x32x16_bf16 v[28:43], v[60:63], v[92:95], v[28:43]
v_mfma_f32_32x32x16_bf16 v[44:59], v[60:63], v[100:103], v[44:59]
v_mfma_f32_32x32x16_bf16 v[28:43], v[64:67], v[96:99], v[28:43]
v_mfma_f32_32x32x16_bf16 v[44:59], v[64:67], v[104:107], v[44:59]
v_mfma_f32_32x32x16_bf16 v[44:59], v[68:71], v[92:95], v[44:59]
v_mfma_f32_32x32x16_bf16 v[44:59], v[72:75], v[96:99], v[44:59]
ds_read_b64 v[60:61], v124 offset:2880
ds_read_b64 v[62:63], v124 offset:2888
ds_read_b64 v[64:65], v124 offset:2912
ds_read_b64 v[66:67], v124 offset:2920
ds_read_b64 v[68:69], v124 offset:832
ds_read_b64 v[70:71], v124 offset:840
ds_read_b64 v[72:73], v124 offset:864
ds_read_b64 v[74:75], v124 offset:872
ds_read_b128 v[92:95], v125 offset:1040
ds_read_b128 v[96:99], v125 offset:1072
ds_read_b128 v[100:103], v125 offset:3600
ds_read_b128 v[104:107], v125 offset:3632
s_waitcnt lgkmcnt(12)
v_mfma_f32_32x32x16_bf16 v[28:43], v[76:79], v[108:111], v[28:43]
v_mfma_f32_32x32x16_bf16 v[44:59], v[76:79], v[116:119], v[44:59]
v_mfma_f32_32x32x16_bf16 v[28:43], v[80:83], v[112:115], v[28:43]
v_mfma_f32_32x32x16_bf16 v[44:59], v[80:83], v[120:123], v[44:59]
v_mfma_f32_32x32x16_bf16 v[44:59], v[84:87], v[108:111], v[44:59]
v_mfma_f32_32x32x16_bf16 v[44:59], v[88:91], v[112:115], v[44:59]
ds_read_b64 v[76:77], v124 offset:2816
ds_read_b64 v[78:79], v124 offset:2824
ds_read_b64 v[80:81], v124 offset:2848
ds_read_b64 v[82:83], v124 offset:2856
ds_read_b64 v[84:85], v124 offset:768
ds_read_b64 v[86:87], v124 offset:776
ds_read_b64 v[88:89], v124 offset:800
ds_read_b64 v[90:91], v124 offset:808
ds_read_b128 v[108:111], v125 offset:960
ds_read_b128 v[112:115], v125 offset:992
ds_read_b128 v[116:119], v125 offset:3520
ds_read_b128 v[120:123], v125 offset:3552
s_waitcnt lgkmcnt(12)
v_mfma_f32_32x32x16_bf16 v[28:43], v[60:63], v[92:95], v[28:43]
v_mfma_f32_32x32x16_bf16 v[44:59], v[60:63], v[100:103], v[44:59]
v_mfma_f32_32x32x16_bf16 v[28:43], v[64:67], v[96:99], v[28:43]
v_mfma_f32_32x32x16_bf16 v[44:59], v[64:67], v[104:107], v[44:59]
v_mfma_f32_32x32x16_bf16 v[44:59], v[68:71], v[92:95], v[44:59]
v_mfma_f32_32x32x16_bf16 v[44:59], v[72:75], v[96:99], v[44:59]
ds_read_b64 v[60:61], v124 offset:2752
ds_read_b64 v[62:63], v124 offset:2760
ds_read_b64 v[64:65], v124 offset:2784
ds_read_b64 v[66:67], v124 offset:2792
ds_read_b64 v[68:69], v124 offset:704
ds_read_b64 v[70:71], v124 offset:712
ds_read_b64 v[72:73], v124 offset:736
ds_read_b64 v[74:75], v124 offset:744
ds_read_b128 v[92:95], v125 offset:880
ds_read_b128 v[96:99], v125 offset:912
ds_read_b128 v[100:103], v125 offset:3440
ds_read_b128 v[104:107], v125 offset:3472
s_waitcnt lgkmcnt(12)
v_mfma_f32_32x32x16_bf16 v[28:43], v[76:79], v[108:111], v[28:43]
v_mfma_f32_32x32x16_bf16 v[44:59], v[76:79], v[116:119], v[44:59]
v_mfma_f32_32x32x16_bf16 v[28:43], v[80:83], v[112:115], v[28:43]
v_mfma_f32_32x32x16_bf16 v[44:59], v[80:83], v[120:123], v[44:59]
v_mfma_f32_32x32x16_bf16 v[44:59], v[84:87], v[108:111], v[44:59]
v_mfma_f32_32x32x16_bf16 v[44:59], v[88:91], v[112:115], v[44:59]
ds_read_b64 v[76:77], v124 offset:2688
ds_read_b64 v[78:79], v124 offset:2696
ds_read_b64 v[80:81], v124 offset:2720
ds_read_b64 v[82:83], v124 offset:2728
ds_read_b64 v[84:85], v124 offset:640
ds_read_b64 v[86:87], v124 offset:648
ds_read_b64 v[88:89], v124 offset:672
ds_read_b64 v[90:91], v124 offset:680
ds_read_b128 v[108:111], v125 offset:800
ds_read_b128 v[112:115], v125 offset:832
ds_read_b128 v[116:119], v125 offset:3360
ds_read_b128 v[120:123], v125 offset:3392
s_waitcnt lgkmcnt(12)
v_mfma_f32_32x32x16_bf16 v[28:43], v[60:63], v[92:95], v[28:43]
v_mfma_f32_32x32x16_bf16 v[44:59], v[60:63], v[100:103], v[44:59]
v_mfma_f32_32x32x16_bf16 v[28:43], v[64:67], v[96:99], v[28:43]
v_mfma_f32_32x32x16_bf16 v[44:59], v[64:67], v[104:107], v[44:59]
v_mfma_f32_32x32x16_bf16 v[44:59], v[68:71], v[92:95], v[44:59]
v_mfma_f32_32x32x16_bf16 v[44:59], v[72:75], v[96:99], v[44:59]
ds_read_b64 v[60:61], v124 offset:2624
ds_read_b64 v[62:63], v124 offset:2632
ds_read_b64 v[64:65], v124 offset:2656
ds_read_b64 v[66:67], v124 offset:2664
ds_read_b64 v[68:69], v124 offset:576
ds_read_b64 v[70:71], v124 offset:584
ds_read_b64 v[72:73], v124 offset:608
ds_read_b64 v[74:75], v124 offset:616
ds_read_b128 v[92:95], v125 offset:720
ds_read_b128 v[96:99], v125 offset:752
ds_read_b128 v[100:103], v125 offset:3280
ds_read_b128 v[104:107], v125 offset:3312
s_waitcnt lgkmcnt(12)
v_mfma_f32_32x32x16_bf16 v[28:43], v[76:79], v[108:111], v[28:43]
v_mfma_f32_32x32x16_bf16 v[44:59], v[76:79], v[116:119], v[44:59]
v_mfma_f32_32x32x16_bf16 v[28:43], v[80:83], v[112:115], v[28:43]
v_mfma_f32_32x32x16_bf16 v[44:59], v[80:83], v[120:123], v[44:59]
v_mfma_f32_32x32x16_bf16 v[44:59], v[84:87], v[108:111], v[44:59]
v_mfma_f32_32x32x16_bf16 v[44:59], v[88:91], v[112:115], v[44:59]
ds_read_b64 v[76:77], v124 offset:2560
ds_read_b64 v[78:79], v124 offset:2568
ds_read_b64 v[80:81], v124 offset:2592
ds_read_b64 v[82:83], v124 offset:2600
ds_read_b64 v[84:85], v124 offset:512
ds_read_b64 v[86:87], v124 offset:520
ds_read_b64 v[88:89], v124 offset:544
ds_read_b64 v[90:91], v124 offset:552
ds_read_b128 v[108:111], v125 offset:640
ds_read_b128 v[112:115], v125 offset:672
ds_read_b128 v[116:119], v125 offset:3200
ds_read_b128 v[120:123], v125 offset:3232
s_waitcnt lgkmcnt(12)
v_mfma_f32_32x32x16_bf16 v[28:43], v[60:63], v[92:95], v[28:43]
v_mfma_f32_32x32x16_bf16 v[44:59], v[60:63], v[100:103], v[44:59]
v_mfma_f32_32x32x16_bf16 v[28:43], v[64:67], v[96:99], v[28:43]
v_mfma_f32_32x32x16_bf16 v[44:59], v[64:67], v[104:107], v[44:59]
v_mfma_f32_32x32x16_bf16 v[44:59], v[68:71], v[92:95], v[44:59]
v_mfma_f32_32x32x16_bf16 v[44:59], v[72:75], v[96:99], v[44:59]
ds_read_b64 v[60:61], v124 offset:2496
ds_read_b64 v[62:63], v124 offset:2504
ds_read_b64 v[64:65], v124 offset:2528
ds_read_b64 v[66:67], v124 offset:2536
ds_read_b64 v[68:69], v124 offset:448
ds_read_b64 v[70:71], v124 offset:456
ds_read_b64 v[72:73], v124 offset:480
ds_read_b64 v[74:75], v124 offset:488
ds_read_b128 v[92:95], v125 offset:560
ds_read_b128 v[96:99], v125 offset:592
ds_read_b128 v[100:103], v125 offset:3120
ds_read_b128 v[104:107], v125 offset:3152
s_waitcnt lgkmcnt(12)
v_mfma_f32_32x32x16_bf16 v[28:43], v[76:79], v[108:111], v[28:43]
v_mfma_f32_32x32x16_bf16 v[44:59], v[76:79], v[116:119], v[44:59]
v_mfma_f32_32x32x16_bf16 v[28:43], v[80:83], v[112:115], v[28:43]
v_mfma_f32_32x32x16_bf16 v[44:59], v[80:83], v[120:123], v[44:59]
v_mfma_f32_32x32x16_bf16 v[44:59], v[84:87], v[108:111], v[44:59]
v_mfma_f32_32x32x16_bf16 v[44:59], v[88:91], v[112:115], v[44:59]
ds_read_b64 v[76:77], v124 offset:2432
ds_read_b64 v[78:79], v124 offset:2440
ds_read_b64 v[80:81], v124 offset:2464
ds_read_b64 v[82:83], v124 offset:2472
ds_read_b64 v[84:85], v124 offset:384
ds_read_b64 v[86:87], v124 offset:392
ds_read_b64 v[88:89], v124 offset:416
ds_read_b64 v[90:91], v124 offset:424
ds_read_b128 v[108:111], v125 offset:480
ds_read_b128 v[112:115], v125 offset:512
ds_read_b128 v[116:119], v125 offset:3040
ds_read_b128 v[120:123], v125 offset:3072
s_waitcnt lgkmcnt(12)
v_mfma_f32_32x32x16_bf16 v[28:43], v[60:63], v[92:95], v[28:43]
v_mfma_f32_32x32x16_bf16 v[44:59], v[60:63], v[100:103], v[44:59]
v_mfma_f32_32x32x16_bf16 v[28:43], v[64:67], v[96:99], v[28:43]
v_mfma_f32_32x32x16_bf16 v[44:59], v[64:67], v[104:107], v[44:59]
v_mfma_f32_32x32x16_bf16 v[44:59], v[68:71], v[92:95], v[44:59]
v_mfma_f32_32x32x16_bf16 v[44:59], v[72:75], v[96:99], v[44:59]
ds_read_b64 v[60:61], v124 offset:2368
ds_read_b64 v[62:63], v124 offset:2376
ds_read_b64 v[64:65], v124 offset:2400
ds_read_b64 v[66:67], v124 offset:2408
ds_read_b64 v[68:69], v124 offset:320
ds_read_b64 v[70:71], v124 offset:328
ds_read_b64 v[72:73], v124 offset:352
ds_read_b64 v[74:75], v124 offset:360
ds_read_b128 v[92:95], v125 offset:400
ds_read_b128 v[96:99], v125 offset:432
ds_read_b128 v[100:103], v125 offset:2960
ds_read_b128 v[104:107], v125 offset:2992
s_waitcnt lgkmcnt(12)
v_mfma_f32_32x32x16_bf16 v[28:43], v[76:79], v[108:111], v[28:43]
v_mfma_f32_32x32x16_bf16 v[44:59], v[76:79], v[116:119], v[44:59]
v_mfma_f32_32x32x16_bf16 v[28:43], v[80:83], v[112:115], v[28:43]
v_mfma_f32_32x32x16_bf16 v[44:59], v[80:83], v[120:123], v[44:59]
v_mfma_f32_32x32x16_bf16 v[44:59], v[84:87], v[108:111], v[44:59]
v_mfma_f32_32x32x16_bf16 v[44:59], v[88:91], v[112:115], v[44:59]
ds_read_b64 v[76:77], v124 offset:2304
ds_read_b64 v[78:79], v124 offset:2312
ds_read_b64 v[80:81], v124 offset:2336
ds_read_b64 v[82:83], v124 offset:2344
ds_read_b64 v[84:85], v124 offset:256
ds_read_b64 v[86:87], v124 offset:264
ds_read_b64 v[88:89], v124 offset:288
ds_read_b64 v[90:91], v124 offset:296
ds_read_b128 v[108:111], v125 offset:320
ds_read_b128 v[112:115], v125 offset:352
ds_read_b128 v[116:119], v125 offset:2880
ds_read_b128 v[120:123], v125 offset:2912
s_waitcnt lgkmcnt(12)
v_mfma_f32_32x32x16_bf16 v[28:43], v[60:63], v[92:95], v[28:43]
v_mfma_f32_32x32x16_bf16 v[44:59], v[60:63], v[100:103], v[44:59]
v_mfma_f32_32x32x16_bf16 v[28:43], v[64:67], v[96:99], v[28:43]
v_mfma_f32_32x32x16_bf16 v[44:59], v[64:67], v[104:107], v[44:59]
v_mfma_f32_32x32x16_bf16 v[44:59], v[68:71], v[92:95], v[44:59]
v_mfma_f32_32x32x16_bf16 v[44:59], v[72:75], v[96:99], v[44:59]
ds_read_b64 v[60:61], v124 offset:2240
ds_read_b64 v[62:63], v124 offset:2248
ds_read_b64 v[64:65], v124 offset:2272
ds_read_b64 v[66:67], v124 offset:2280
ds_read_b64 v[68:69], v124 offset:192
ds_read_b64 v[70:71], v124 offset:200
ds_read_b64 v[72:73], v124 offset:224
ds_read_b64 v[74:75], v124 offset:232
ds_read_b128 v[92:95], v125 offset:240
ds_read_b128 v[96:99], v125 offset:272
ds_read_b128 v[100:103], v125 offset:2800
ds_read_b128 v[104:107], v125 offset:2832
s_waitcnt lgkmcnt(12)
v_mfma_f32_32x32x16_bf16 v[28:43], v[76:79], v[108:111], v[28:43]
v_mfma_f32_32x32x16_bf16 v[44:59], v[76:79], v[116:119], v[44:59]
v_mfma_f32_32x32x16_bf16 v[28:43], v[80:83], v[112:115], v[28:43]
v_mfma_f32_32x32x16_bf16 v[44:59], v[80:83], v[120:123], v[44:59]
v_mfma_f32_32x32x16_bf16 v[44:59], v[84:87], v[108:111], v[44:59]
v_mfma_f32_32x32x16_bf16 v[44:59], v[88:91], v[112:115], v[44:59]
ds_read_b64 v[76:77], v124 offset:2176
ds_read_b64 v[78:79], v124 offset:2184
ds_read_b64 v[80:81], v124 offset:2208
ds_read_b64 v[82:83], v124 offset:2216
ds_read_b64 v[84:85], v124 offset:128
ds_read_b64 v[86:87], v124 offset:136
ds_read_b64 v[88:89], v124 offset:160
ds_read_b64 v[90:91], v124 offset:168
ds_read_b128 v[108:111], v125 offset:160
ds_read_b128 v[112:115], v125 offset:192
ds_read_b128 v[116:119], v125 offset:2720
ds_read_b128 v[120:123], v125 offset:2752
s_waitcnt lgkmcnt(12)
v_mfma_f32_32x32x16_bf16 v[28:43], v[60:63], v[92:95], v[28:43]
v_mfma_f32_32x32x16_bf16 v[44:59], v[60:63], v[100:103], v[44:59]
v_mfma_f32_32x32x16_bf16 v[28:43], v[64:67], v[96:99], v[28:43]
v_mfma_f32_32x32x16_bf16 v[44:59], v[64:67], v[104:107], v[44:59]
v_mfma_f32_32x32x16_bf16 v[44:59], v[68:71], v[92:95], v[44:59]
v_mfma_f32_32x32x16_bf16 v[44:59], v[72:75], v[96:99], v[44:59]
ds_read_b64 v[60:61], v124 offset:2112
ds_read_b64 v[62:63], v124 offset:2120
ds_read_b64 v[64:65], v124 offset:2144
ds_read_b64 v[66:67], v124 offset:2152
ds_read_b64 v[68:69], v124 offset:64
ds_read_b64 v[70:71], v124 offset:72
ds_read_b64 v[72:73], v124 offset:96
ds_read_b64 v[74:75], v124 offset:104
ds_read_b128 v[92:95], v125 offset:80
ds_read_b128 v[96:99], v125 offset:112
ds_read_b128 v[100:103], v125 offset:2640
ds_read_b128 v[104:107], v125 offset:2672
s_waitcnt lgkmcnt(12)
v_mfma_f32_32x32x16_bf16 v[28:43], v[76:79], v[108:111], v[28:43]
v_mfma_f32_32x32x16_bf16 v[44:59], v[76:79], v[116:119], v[44:59]
v_mfma_f32_32x32x16_bf16 v[28:43], v[80:83], v[112:115], v[28:43]
v_mfma_f32_32x32x16_bf16 v[44:59], v[80:83], v[120:123], v[44:59]
v_mfma_f32_32x32x16_bf16 v[44:59], v[84:87], v[108:111], v[44:59]
v_mfma_f32_32x32x16_bf16 v[44:59], v[88:91], v[112:115], v[44:59]
ds_read_b64 v[76:77], v124 offset:2048
ds_read_b64 v[78:79], v124 offset:2056
ds_read_b64 v[80:81], v124 offset:2080
ds_read_b64 v[82:83], v124 offset:2088
ds_read_b64 v[84:85], v124 offset:0
ds_read_b64 v[86:87], v124 offset:8
ds_read_b64 v[88:89], v124 offset:32
ds_read_b64 v[90:91], v124 offset:40
ds_read_b128 v[108:111], v125 offset:0
ds_read_b128 v[112:115], v125 offset:32
ds_read_b128 v[116:119], v125 offset:2560
ds_read_b128 v[120:123], v125 offset:2592
s_waitcnt lgkmcnt(12)
v_mfma_f32_32x32x16_bf16 v[28:43], v[60:63], v[92:95], v[28:43]
v_mfma_f32_32x32x16_bf16 v[44:59], v[60:63], v[100:103], v[44:59]
v_mfma_f32_32x32x16_bf16 v[28:43], v[64:67], v[96:99], v[28:43]
v_mfma_f32_32x32x16_bf16 v[44:59], v[64:67], v[104:107], v[44:59]
v_mfma_f32_32x32x16_bf16 v[44:59], v[68:71], v[92:95], v[44:59]
v_mfma_f32_32x32x16_bf16 v[44:59], v[72:75], v[96:99], v[44:59]
s_waitcnt lgkmcnt(0)
v_mfma_f32_32x32x16_bf16 v[28:43], v[76:79], v[108:111], v[28:43]
v_mfma_f32_32x32x16_bf16 v[44:59], v[76:79], v[116:119], v[44:59]
v_mfma_f32_32x32x16_bf16 v[28:43], v[80:83], v[112:115], v[28:43]
v_mfma_f32_32x32x16_bf16 v[44:59], v[80:83], v[120:123], v[44:59]
v_mfma_f32_32x32x16_bf16 v[44:59], v[84:87], v[108:111], v[44:59]
v_mfma_f32_32x32x16_bf16 v[44:59], v[88:91], v[112:115], v[44:59]
s_setprio 3
s_lshl_b32 s40, s36, 12
s_add_u32 s40, s40, 50688
v_lshlrev_b32 v152, 4, v1
v_add_u32 v152, s40, v152
s_xor_b32 s41, s36, 1
s_lshl_b32 s41, s41, 12
s_add_u32 s41, s41, 50688
v_lshlrev_b32 v153, 4, v1
v_add_u32 v153, s41, v153
v_mul_u32_u24 v154, 80, v3
v_lshl_add_u32 v154, v2, 3, v154
s_mul_i32 s40, s38, 2560
s_add_u32 s40, s40, s45
s_add_u32 s40, s40, 20144
v_add_u32 v154, s40, v154
v_and_b32 v155, 15, v1
v_lshlrev_b32 v155, 6, v155
v_lshl_add_u32 v155, v2, 4, v155
v_bfe_u32 v153, v1, 4, 1
v_lshl_add_u32 v155, v153, 5, v155
v_lshlrev_b32 v153, 4, v1
v_add_u32 v153, s41, v153
ds_read_b64 v[144:145], v154 offset:0
ds_read_b64 v[146:147], v154 offset:16
ds_read_b64 v[148:149], v154 offset:32
ds_read_b64 v[150:151], v154 offset:48
s_cmp_eq_u32 s38, 1
s_cbranch_scc1 fz_cf1_35
s_nop 7
s_nop 3
ds_write_b128 v152, v[44:47] offset:0
ds_write_b128 v152, v[48:51] offset:1024
ds_write_b128 v152, v[52:55] offset:2048
ds_write_b128 v152, v[56:59] offset:3072
s_waitcnt lgkmcnt(0)
s_barrier
ds_read_b128 v[128:131], v153 offset:0
ds_read_b128 v[132:135], v153 offset:1024
ds_read_b128 v[136:139], v153 offset:2048
ds_read_b128 v[140:143], v153 offset:3072
s_waitcnt lgkmcnt(0)
v_add_f32 v28, v28, v128
v_add_f32 v29, v29, v129
v_add_f32 v30, v30, v130
v_add_f32 v31, v31, v131
v_add_f32 v32, v32, v132
v_add_f32 v33, v33, v133
v_add_f32 v34, v34, v134
v_add_f32 v35, v35, v135
v_add_f32 v36, v36, v136
v_add_f32 v37, v37, v137
v_add_f32 v38, v38, v138
v_add_f32 v39, v39, v139
v_add_f32 v40, v40, v140
v_add_f32 v41, v41, v141
v_add_f32 v42, v42, v142
v_add_f32 v43, v43, v143
v_lshlrev_b32 v128, 16, v144
v_and_b32 v129, 0xffff0000, v144
v_fma_f32 v128, v128, s43, v28
v_fma_f32 v129, v129, s43, v29
v_cvt_pk_bf16_f32 v144, v128, v129
v_lshlrev_b32 v128, 16, v145
v_and_b32 v129, 0xffff0000, v145
v_fma_f32 v128, v128, s43, v30
v_fma_f32 v129, v129, s43, v31
v_cvt_pk_bf16_f32 v145, v128, v129
v_lshlrev_b32 v128, 16, v146
v_and_b32 v129, 0xffff0000, v146
v_fma_f32 v128, v128, s43, v32
v_fma_f32 v129, v129, s43, v33
v_cvt_pk_bf16_f32 v146, v128, v129
v_lshlrev_b32 v128, 16, v147
v_and_b32 v129, 0xffff0000, v147
v_fma_f32 v128, v128, s43, v34
v_fma_f32 v129, v129, s43, v35
v_cvt_pk_bf16_f32 v147, v128, v129
v_lshlrev_b32 v128, 16, v148
v_and_b32 v129, 0xffff0000, v148
v_fma_f32 v128, v128, s43, v36
v_fma_f32 v129, v129, s43, v37
v_cvt_pk_bf16_f32 v148, v128, v129
v_lshlrev_b32 v128, 16, v149
v_and_b32 v129, 0xffff0000, v149
v_fma_f32 v128, v128, s43, v38
v_fma_f32 v129, v129, s43, v39
v_cvt_pk_bf16_f32 v149, v128, v129
v_lshlrev_b32 v128, 16, v150
v_and_b32 v129, 0xffff0000, v150
v_fma_f32 v128, v128, s43, v40
v_fma_f32 v129, v129, s43, v41
v_cvt_pk_bf16_f32 v150, v128, v129
v_lshlrev_b32 v128, 16, v151
v_and_b32 v129, 0xffff0000, v151
v_fma_f32 v128, v128, s43, v42
v_fma_f32 v129, v129, s43, v43
v_cvt_pk_bf16_f32 v151, v128, v129
s_branch fz_cfj_36
fz_cf1_35:
s_nop 7
s_nop 3
ds_write_b128 v152, v[28:31] offset:0
ds_write_b128 v152, v[32:35] offset:1024
ds_write_b128 v152, v[36:39] offset:2048
ds_write_b128 v152, v[40:43] offset:3072
s_waitcnt lgkmcnt(0)
s_barrier
ds_read_b128 v[128:131], v153 offset:0
ds_read_b128 v[132:135], v153 offset:1024
ds_read_b128 v[136:139], v153 offset:2048
ds_read_b128 v[140:143], v153 offset:3072
s_waitcnt lgkmcnt(0)
v_add_f32 v44, v44, v128
v_add_f32 v45, v45, v129
v_add_f32 v46, v46, v130
v_add_f32 v47, v47, v131
v_add_f32 v48, v48, v132
v_add_f32 v49, v49, v133
v_add_f32 v50, v50, v134
v_add_f32 v51, v51, v135
v_add_f32 v52, v52, v136
v_add_f32 v53, v53, v137
v_add_f32 v54, v54, v138
v_add_f32 v55, v55, v139
v_add_f32 v56, v56, v140
v_add_f32 v57, v57, v141
v_add_f32 v58, v58, v142
v_add_f32 v59, v59, v143
v_lshlrev_b32 v128, 16, v144
v_and_b32 v129, 0xffff0000, v144
v_fma_f32 v128, v128, s43, v44
v_fma_f32 v129, v129, s43, v45
v_cvt_pk_bf16_f32 v144, v128, v129
v_lshlrev_b32 v128, 16, v145
v_and_b32 v129, 0xffff0000, v145
v_fma_f32 v128, v128, s43, v46
v_fma_f32 v129, v129, s43, v47
v_cvt_pk_bf16_f32 v145, v128, v129
v_lshlrev_b32 v128, 16, v146
v_and_b32 v129, 0xffff0000, v146
v_fma_f32 v128, v128, s43, v48
v_fma_f32 v129, v129, s43, v49
v_cvt_pk_bf16_f32 v146, v128, v129
v_lshlrev_b32 v128, 16, v147
v_and_b32 v129, 0xffff0000, v147
v_fma_f32 v128, v128, s43, v50
v_fma_f32 v129, v129, s43, v51
v_cvt_pk_bf16_f32 v147, v128, v129
v_lshlrev_b32 v128, 16, v148
v_and_b32 v129, 0xffff0000, v148
v_fma_f32 v128, v128, s43, v52
v_fma_f32 v129, v129, s43, v53
v_cvt_pk_bf16_f32 v148, v128, v129
v_lshlrev_b32 v128, 16, v149
v_and_b32 v129, 0xffff0000, v149
v_fma_f32 v128, v128, s43, v54
v_fma_f32 v129, v129, s43, v55
v_cvt_pk_bf16_f32 v149, v128, v129
v_lshlrev_b32 v128, 16, v150
v_and_b32 v129, 0xffff0000, v150
v_fma_f32 v128, v128, s43, v56
v_fma_f32 v129, v129, s43, v57
v_cvt_pk_bf16_f32 v150, v128, v129
v_lshlrev_b32 v128, 16, v151
v_and_b32 v129, 0xffff0000, v151
v_fma_f32 v128, v128, s43, v58
v_fma_f32 v129, v129, s43, v59
v_cvt_pk_bf16_f32 v151, v128, v129
fz_cfj_36:
v_permlane32_swap_b32 v144, v146
v_permlane32_swap_b32 v145, v147
v_permlane32_swap_b32 v148, v150
v_permlane32_swap_b32 v149, v151
s_nop 0
v_permlane16_swap_b32 v144, v148
v_permlane16_swap_b32 v145, v149
v_permlane16_swap_b32 v146, v150
v_permlane16_swap_b32 v147, v151
buffer_store_dwordx4 v[144:147], v155, s[32:35], s44 offen sc1
buffer_store_dwordx4 v[148:151], v155, s[32:35], s44 offen offset:1024 sc1
s_lshl_b32 s50, s2, 7
s_add_u32 s50, s50, 65536
s_waitcnt vmcnt(0)
s_barrier
s_cmp_lg_u32 s36, 0
s_cbranch_scc1 fz_fl_37
v_mov_b32 v204, s64
s_mov_b64 exec, 1
buffer_store_dword v204, off, s[68:71], s50 sc1
s_mov_b64 exec, -1
fz_fl_37:
s_endpgm
fz_end:
s_endpgm
.section .rodata,"a"
.p2align 6
.amdhsa_kernel gated_mix__ssm_conv_s4__glu_gated_reglu__prompt_kernel
  .amdhsa_next_free_vgpr 248
  .amdhsa_next_free_sgpr 102
  .amdhsa_accum_offset 248
  .amdhsa_group_segment_fixed_size 0
  .amdhsa_kernarg_size 136
  .amdhsa_user_sgpr_count 2
  .amdhsa_user_sgpr_kernarg_segment_ptr 1
  .amdhsa_system_sgpr_workgroup_id_x 1
.end_amdhsa_kernel
```
